```python
import torch

def _softmax(x, axis=-1):
    return torch.softmax(x, dim=axis)
def _gelu(x):
    return torch.nn.functional.gelu(x, approximate="tanh")
def _silu(x):
    return torch.nn.functional.silu(x)
def _sigmoid(x):
    return torch.sigmoid(x)
def _layernorm(x, axis=-1, eps=1e-5):
    m = x.mean(dim=axis, keepdim=True)
    v = x.var(dim=axis, keepdim=True, unbiased=False)
    return (x - m) / torch.sqrt(v + eps)
def _scatter_add(tgt, idx, src, axis=0):
    return tgt.clone().index_add_(axis, idx, src)
def _segment_sum(src, seg, n):
    out = torch.zeros((n,) + src.shape[1:], dtype=src.dtype)
    return out.index_add_(0, seg, src)
def _pad(x, pw):
    flat = tuple(v for pair in reversed(pw) for v in pair)
    return torch.nn.functional.pad(x, flat)

kernel_name = 'sequential_preLN__linear_kernel_hedgehog__dense_activation_mish__prompt'

def setup_inputs():

    _w = (lambda a: (lambda t: t.to(torch.bfloat16) if t.is_floating_point() else t)(torch.as_tensor(a)))
    def _A_setup():
        B, S, D, H = 1, 2048, 512, 32
        Dh = D // H
        return {
            "x": _w((lambda *s: torch.randn(*s, dtype=torch.bfloat16) * 0.05)(B, S, D)),
            "wqkv": _w((lambda *s: torch.randn(*s, dtype=torch.bfloat16) * 0.2)(D, 3 * D)),
            "w_phi": _w((lambda *s: torch.randn(*s, dtype=torch.bfloat16) * 0.2)(H, Dh, Dh) * (Dh ** -0.5)),
            "wo": _w((lambda *s: torch.randn(*s, dtype=torch.bfloat16) * 0.05)(D, D)),
        }
    _A_in = _A_setup()

    def _B_setup():
        B, S, D, F = 1, 2048, 512, 1792
        return {
            "x": _w((lambda *s: torch.randn(*s, dtype=torch.bfloat16) * 0.05)(B, S, D)),
            "w1": _w((lambda *s: torch.randn(*s, dtype=torch.bfloat16) * 1.6)(D, F) * (D ** -0.5)),
            "b1": _w((lambda *s: torch.randn(*s, dtype=torch.bfloat16) * 0.4)(F)),
            "w2": _w((lambda *s: torch.randn(*s, dtype=torch.bfloat16) * 0.1)(F, D) * (F ** -0.5)),
        }
    _B_in = _B_setup()

    return {
        "A_x": _A_in["x"],
        "A_wqkv": _A_in["wqkv"],
        "A_w_phi": _A_in["w_phi"],
        "A_wo": _A_in["wo"],
        "B_x": _B_in["x"],
        "B_w1": _B_in["w1"],
        "B_b1": _B_in["b1"],
        "B_w2": _B_in["w2"],
    }

def reference(A_x, A_wqkv, A_w_phi, A_wo, B_x, B_w1, B_b1, B_w2):
    def _A_ref(x, wqkv, w_phi, wo):
        B, S, D = x.shape
        H = 32; Dh = D // H
        qkv = (lambda x, *d: x.permute(*d))((x @ wqkv).reshape(B, S, 3, H, Dh), 2, 0, 3, 1, 4)
        q, k, v = qkv[0], qkv[1], qkv[2]
        pq = torch.einsum("bhsd,hdf->bhsf", q, w_phi)
        pk = torch.einsum("bhsd,hdf->bhsf", k, w_phi)
        phi_q = torch.concatenate([_softmax(pq, axis=-1), _softmax(-pq, axis=-1)], axis=-1)
        phi_k = torch.concatenate([_softmax(pk, axis=-1), _softmax(-pk, axis=-1)], axis=-1)
        kv = torch.einsum("bhsf,bhsd->bhfd", phi_k, v)
        z  = torch.einsum("bhsf->bhf", phi_k)
        num = torch.einsum("bhqf,bhfd->bhqd", phi_q, kv)
        den = torch.einsum("bhqf,bhf->bhq", phi_q, z)[..., None] + 1e-6
        o = num / den
        return (lambda x, *d: x.permute(*d))(o, 0, 2, 1, 3).reshape(B, S, D) @ wo

    def _B_ref(x, w1, b1, w2):
        h = torch.einsum("bsd,df->bsf", x, w1) + b1
        sp = torch.log1p(torch.exp(-torch.abs(h))) + torch.where(h > 0, h, torch.zeros_like(h))
        act = h * torch.tanh(sp)
        return torch.einsum("bsf,fd->bsd", act, w2)

    x = A_x
    h = x + _A_ref(_layernorm(x, axis=-1), A_wqkv, A_w_phi, A_wo)
    h2 = h + _B_ref(_layernorm(h, axis=-1), B_w1, B_b1, B_w2)
    return h2
```

```asm
; @launch grid=(256,1,1) block=(256,1,1) lds=163840
.amdgcn_target "amdgcn-amd-amdhsa--gfx950"
.text
.globl sequential_preLN__linear_kernel_hedgehog__dense_activation_mish__prompt_kernel
.p2align 8
.type sequential_preLN__linear_kernel_hedgehog__dense_activation_mish__prompt_kernel,@function
sequential_preLN__linear_kernel_hedgehog__dense_activation_mish__prompt_kernel:
    s_cmp_ge_u32 s2, 256
    s_cbranch_scc1 L_end
    s_load_dwordx16 s[64:79], s[0:1], 0
    s_load_dwordx4 s[80:83], s[0:1], 64
    s_load_dwordx2 s[84:85], s[0:1], 80
    s_getpc_b64 s[52:53]
L_pc:
    s_lshr_b32 s50, s2, 3
    v_lshrrev_b32 v28, 6, v0
    v_and_b32 v1, 63, v0
    v_readfirstlane_b32 s46, v28
    s_mul_i32 s51, s50, 1152
    v_lshl_add_u32 v29, v0, 7, s51
    v_min_u32 v29, L_end-L_pc, v29
    v_cmp_gt_u32 vcc, 9, v0
    s_nop 0
    s_and_saveexec_b64 s[62:63], vcc
    s_cbranch_execz L_nocp
    global_load_dword v255, v29, s[52:53]
L_nocp:
    s_mov_b64 exec, -1
    s_and_b32 s60, s2, 7
    s_and_b32 s45, s50, 15
    s_lshr_b32 s52, s50, 4
    s_lshl_b32 s44, s60, 1
    s_add_u32 s44, s44, s52
    s_and_b32 s53, s45, 1
    s_lshr_b32 s51, s45, 1
    s_and_b32 s50, s60, 1
    s_lshl_b32 s87, s52, 2
    s_lshl_b32 s88, s53, 1
    s_add_u32 s87, s87, s88
    s_add_u32 s87, s87, s51
    s_add_u32 s87, s87, s50
    s_and_b32 s87, s87, 7
    s_lshl_b32 s48, s87, 7
    s_mul_i32 s49, s87, 196608
    s_lshl_b32 s50, s44, 17
    s_lshl_b32 s88, s46, 15
    s_add_u32 s50, s50, s88
    s_add_u32 s50, s50, 2048
    s_lshl_b32 s57, s46, 14
    s_add_u32 s57, s57, 65536
    s_lshl_b32 s58, s46, 11
    v_lshrrev_b32 v29, 4, v1
    v_and_b32 v30, 7, v1
    v_xor_b32 v29, v29, v30
    v_lshrrev_b32 v31, 3, v1
    v_lshlrev_b32 v6, 10, v31
    v_lshl_add_u32 v6, v29, 4, v6
    v_add_u32 v6, s50, v6
    v_xor_b32 v7, 64, v6
    s_lshl_b32 s51, s53, 14
    s_sub_u32 s52, 14336, s51
    v_add_u32 v7, 7168, v7
    v_add_u32 v8, s52, v6
    v_add_u32 v9, s52, v7
    v_add_u32 v6, s51, v6
    v_add_u32 v7, s51, v7
    s_lshl_b32 s52, s45, 6
    v_lshrrev_b32 v31, 2, v0
    v_mul_u32_u24 v11, 3072, v31
    v_bfe_u32 v31, v1, 0, 2
    v_lshl_add_u32 v11, v31, 4, v11
    v_add_u32 v11, s52, v11
    v_add_u32 v10, 1024, v11
    s_waitcnt lgkmcnt(0)
    s_mov_b32 s8, s66
    s_and_b32 s9, s67, 0xffff
    s_mov_b32 s10, 0x180000
    s_mov_b32 s11, 0x20000
    s_load_dword s36, s[84:85], 0x38000
    s_add_u32 m0, s58, 0
    s_nop 0
    buffer_load_dwordx4 v10, s[8:11], s49 offen lds
    buffer_load_dwordx4 v10, s[8:11], s49 offen offset:1024 lds
    s_add_u32 s49, s49, 196608
    s_cmp_eq_u32 s49, 1572864
    s_cmov_b32 s49, 0
    s_sub_u32 s64, s64, 2048
    s_subb_u32 s65, s65, 0
    s_mov_b32 s4, s64
    s_and_b32 s5, s65, 0xffff
    s_mov_b32 s6, 0x200800
    s_mov_b32 s7, 0x20000
    s_add_u32 m0, s57, 0
    s_nop 0
    buffer_load_dwordx4 v6, s[4:7], s48 offen offset:0 lds
    buffer_load_dwordx4 v7, s[4:7], s48 offen offset:1024 lds
    s_lshr_b32 s51, s2, 3
    s_lshl_b32 s52, s2, 4
    s_lshl_b32 s88, s46, 2
    s_add_u32 s52, s52, s88
    s_lshl_b32 s51, s51, 4
    s_lshl_b32 s88, s46, 2
    s_add_u32 s51, s51, s88
    v_and_b32 v28, 3, v1
    v_add_u32 v29, s52, v28
    v_add_u32 v28, s51, v28
    v_cmp_gt_u32 vcc, 4, v1
    v_lshrrev_b32 v31, 3, v29
    v_mul_u32_u24 v48, 3072, v31
    v_bfe_u32 v31, v29, 0, 3
    v_lshl_add_u32 v48, v31, 7, v48
    v_mul_u32_u24 v49, 3072, v28
    v_add_u32 v49, 384, v49
    v_cndmask_b32 v48, v49, v48, vcc
    v_lshlrev_b32 v50, 7, v29
    v_lshlrev_b32 v49, 10, v28
    v_add_u32 v49, 384, v49
    v_cndmask_b32 v49, v49, v50, vcc
    v_lshlrev_b32 v2, 4, v1
    s_mov_b32 s16, s70
    s_and_b32 s17, s71, 0xffff
    s_mov_b32 s18, 0x80000
    s_mov_b32 s19, 0x20000
    s_mov_b32 s12, s68
    s_and_b32 s13, s69, 0xffff
    s_mov_b32 s14, 0x4000
    s_mov_b32 s15, 0x20000
    s_mov_b64 exec, 0xf
    buffer_load_dword v254, v48, s[8:11], 0 offen
    buffer_load_dword v253, v49, s[16:19], 0 offen
    s_mov_b64 exec, 0xf0
    buffer_load_dword v252, v48, s[8:11], 0 offen offset:1024
    buffer_load_dword v251, v48, s[8:11], 0 offen offset:2048
    s_lshl_b32 s52, s45, 10
    s_lshl_b32 s88, s46, 8
    s_add_u32 s52, s52, s88
    s_lshl_b32 s53, s46, 8
    s_add_u32 s53, s53, 162816
    s_mov_b32 m0, s53
    s_mov_b64 exec, 0xffff
    buffer_load_dwordx4 v2, s[12:15], s52 offen lds
    s_mov_b64 exec, -1
    s_add_u32 m0, s57, 0
    s_nop 0
    buffer_load_dwordx4 v8, s[4:7], s48 offen offset:2048 lds
    buffer_load_dwordx4 v9, s[4:7], s48 offen offset:3072 lds
    s_add_u32 s48, s48, 128
    s_and_b32 s48, s48, 1023
    s_mov_b32 s40, s84
    s_and_b32 s41, s85, 0xffff
    s_mov_b32 s42, 0x10000000
    s_mov_b32 s43, 0x20000
    s_mov_b32 s20, s74
    s_and_b32 s21, s75, 0xffff
    s_mov_b32 s22, 0x1c0000
    s_mov_b32 s23, 0x20000
    s_mov_b32 s24, s76
    s_and_b32 s25, s77, 0xffff
    s_mov_b32 s26, 0xe00
    s_mov_b32 s27, 0x20000
    s_mov_b32 s28, s78
    s_and_b32 s29, s79, 0xffff
    s_mov_b32 s30, 0x1c0000
    s_mov_b32 s31, 0x20000
    s_mov_b32 s32, s80
    s_and_b32 s33, s81, 0xffff
    s_mov_b32 s34, 0x200000
    s_mov_b32 s35, 0x20000
    s_mov_b32 s92, s74
    s_and_b32 s93, s75, 0xffff
    s_mov_b32 s94, 0x1c0000
    s_mov_b32 s95, 0x20000
    s_mov_b32 s54, 0x3f803f80
    s_mov_b32 s55, 0x3f80
    s_mov_b32 s56, 0x3f800000
    s_mov_b32 s59, 0
    s_mov_b32 s37, 131200
    s_mov_b32 s3, 0x3f3504f3
    s_mov_b32 s84, 0x3f317218
    s_lshr_b32 s89, s46, 1
    s_and_b32 s90, s46, 1
    s_and_b32 s61, s45, 1
    s_lshr_b32 s47, s45, 1
    s_and_b32 s52, s47, 3
    s_cmp_eq_u32 s52, 3
    s_cselect_b32 s52, 4, 0
    s_xor_b32 s47, s47, s52
    s_lshl_b32 s86, s46, 13
    s_lshl_b32 s91, s46, 12
    v_lshrrev_b32 v32, 5, v1
    v_lshlrev_b32 v3, 2, v1
    v_bfe_u32 v31, v1, 0, 1
    v_lshlrev_b32 v72, 9, v31
    v_bfe_u32 v31, v1, 1, 1
    v_lshl_add_u32 v72, v31, 3, v72
    v_bfe_u32 v31, v1, 4, 1
    v_lshl_add_u32 v72, v31, 4, v72
    v_bfe_u32 v31, v1, 2, 2
    v_lshl_add_u32 v72, v31, 5, v72
    v_lshl_add_u32 v72, v32, 7, v72
    v_add_u32 v72, 162816, v72
    v_bfe_u32 v28, v1, 2, 1
    v_cmp_eq_u32 s[62:63], 0, v28
    v_bfe_u32 v29, v1, 1, 3
    s_lshl_b32 s52, s46, 1
    v_add_u32 v30, s52, v32
    v_xor_b32 v29, v29, v30
    v_bfe_u32 v31, v1, 0, 5
    v_lshlrev_b32 v12, 7, v31
    v_lshl_add_u32 v12, v29, 4, v12
    v_add_u32 v12, s57, v12
    s_and_b32 s52, s45, 1
    s_lshl_b32 s52, s52, 11
    v_xor_b32 v12, s52, v12
    v_xor_b32 v13, 32, v12
    v_xor_b32 v14, 64, v12
    v_xor_b32 v15, 96, v12
    v_bfe_u32 v31, v1, 0, 5
    v_lshlrev_b32 v5, 10, v31
    v_lshl_add_u32 v5, v32, 5, v5
    v_bfe_u32 v31, v1, 2, 2
    v_lshlrev_b32 v16, 6, v31
    v_bfe_u32 v31, v1, 4, 1
    v_lshl_add_u32 v16, v31, 5, v16
    v_bfe_u32 v31, v1, 0, 2
    v_lshl_add_u32 v16, v31, 3, v16
    v_lshl_add_u32 v16, v32, 9, v16
    v_add_u32 v16, s58, v16
    v_xor_b32 v17, 2048, v16
    v_xor_b32 v18, 4096, v16
    v_xor_b32 v19, 6144, v16
    v_bfe_u32 v31, v1, 2, 2
    v_lshlrev_b32 v33, 6, v31
    v_bfe_u32 v31, v1, 0, 1
    v_lshl_add_u32 v33, v31, 5, v33
    v_bfe_u32 v31, v1, 4, 1
    v_lshl_add_u32 v33, v31, 4, v33
    v_bfe_u32 v31, v1, 1, 1
    v_lshl_add_u32 v33, v31, 3, v33
    s_mul_i32 s52, s89, 33280
    s_add_u32 s52, s52, 65536
    v_lshlrev_b32 v28, 0, v33
    v_lshl_add_u32 v28, v32, 10, v28
    v_add_u32 v28, s52, v28
    v_accvgpr_write_b32 a232, v28
    s_lshl_b32 s52, s46, 9
    v_lshlrev_b32 v28, 0, v33
    v_lshl_add_u32 v28, v32, 12, v28
    v_add_u32 v28, s52, v28
    v_accvgpr_write_b32 a233, v28
    s_lshl_b32 s52, s89, 9
    s_add_u32 s52, s52, s86
    v_lshlrev_b32 v28, 0, v33
    v_lshl_add_u32 v28, v32, 11, v28
    v_add_u32 v28, s52, v28
    v_accvgpr_write_b32 a234, v28
    v_bfe_u32 v31, v1, 0, 2
    v_lshlrev_b32 v29, 4, v31
    v_lshl_add_u32 v29, v32, 6, v29
    s_lshl_b32 s52, s89, 18
    s_lshl_b32 s88, s47, 7
    s_add_u32 s52, s52, s88
    v_bfe_u32 v31, v1, 2, 3
    v_lshlrev_b32 v28, 10, v31
    v_lshl_add_u32 v28, v29, 0, v28
    v_add_u32 v28, s52, v28
    v_accvgpr_write_b32 a235, v28
    s_mul_i32 s52, s61, 917504
    s_mul_i32 s88, s46, 229376
    s_add_u32 s52, s52, s88
    s_lshl_b32 s88, s47, 7
    s_add_u32 s52, s52, s88
    v_bfe_u32 v31, v1, 2, 3
    v_lshlrev_b32 v28, 10, v31
    v_lshl_add_u32 v28, v29, 0, v28
    v_add_u32 v28, s52, v28
    v_accvgpr_write_b32 a236, v28
    s_add_u32 s53, s45, -14
    s_cselect_b32 s53, s53, s45
    s_mul_i32 s52, s46, 57344
    s_lshl_b32 s88, s45, 8
    s_add_u32 s52, s52, s88
    s_add_u32 s52, s52, 3072
    v_bfe_u32 v31, v1, 2, 3
    v_mul_u32_u24 v28, 3584, v31
    v_lshl_add_u32 v28, v29, 0, v28
    v_add_u32 v28, s52, v28
    v_accvgpr_write_b32 a237, v28
    v_bfe_u32 v28, v1, 1, 2
    v_bfe_u32 v31, v1, 3, 1
    v_lshlrev_b32 v29, 1, v31
    v_xor_b32 v29, v28, v29
    v_bfe_u32 v31, v1, 0, 5
    v_lshlrev_b32 v28, 6, v31
    v_lshl_add_u32 v28, v29, 4, v28
    v_add_u32 v28, s58, v28
    v_lshl_add_u32 v20, v32, 3, v28
    v_lshl_add_u32 v24, v32, 13, v28
    v_xor_b32 v21, 16, v20
    v_xor_b32 v25, 16, v24
    v_xor_b32 v22, 32, v20
    v_xor_b32 v26, 32, v24
    v_xor_b32 v23, 48, v20
    v_xor_b32 v27, 48, v24
    v_bfe_u32 v31, v1, 3, 1
    v_lshlrev_b32 v28, 0, v31
    v_bfe_u32 v31, v1, 4, 1
    v_lshl_add_u32 v28, v31, 1, v28
    v_bfe_u32 v29, v1, 1, 1
    v_xor_b32 v28, v28, v29
    v_lshrrev_b32 v31, 4, v1
    v_lshlrev_b32 v30, 9, v31
    v_bfe_u32 v31, v1, 2, 2
    v_lshl_add_u32 v30, v31, 6, v30
    v_lshl_add_u32 v30, v28, 4, v30
    v_bfe_u32 v31, v1, 0, 1
    v_lshl_add_u32 v30, v31, 3, v30
    s_lshl_b32 s52, s89, 5
    s_lshl_b32 s88, s90, 13
    s_add_u32 s52, s52, s88
    v_xor_b32 v28, s52, v30
    v_accvgpr_write_b32 a238, v28
    s_lshl_b32 s52, s90, 5
    v_xor_b32 v28, s52, v30
    v_accvgpr_write_b32 a239, v28
    v_lshrrev_b32 v31, 4, v0
    v_lshlrev_b32 v28, 4, v31
    v_accvgpr_write_b32 a240, v28
    v_bfe_u32 v31, v1, 0, 4
    v_mul_u32_u24 v29, 2304, v31
    v_lshl_add_u32 v29, v28, 0, v29
    v_accvgpr_write_b32 a241, v29
    s_mul_i32 s52, s90, 1360
    s_lshl_b32 s88, s89, 5
    s_add_u32 s52, s52, s88
    s_add_u32 s52, s52, 147456
    v_lshrrev_b32 v31, 4, v1
    v_lshlrev_b32 v28, 3, v31
    v_add_u32 v28, s52, v28
    v_accvgpr_write_b32 a242, v28
    v_bfe_u32 v31, v1, 0, 3
    v_mul_u32_u24 v29, 160, v31
    v_mul_u32_u24 v31, 80, v32
    v_add_u32 v29, v31, v29
    v_bfe_u32 v31, v1, 3, 2
    v_lshl_add_u32 v29, v31, 3, v29
    v_add_u32 v29, s52, v29
    v_accvgpr_write_b32 a243, v29
    s_lshl_b32 s53, s46, 9
    v_bfe_u32 v31, v1, 0, 5
    v_lshlrev_b32 v29, 4, v31
    v_mul_u32_u24 v31, 2304, v32
    v_add_u32 v29, v31, v29
    v_add_u32 v29, s53, v29
    v_accvgpr_write_b32 a244, v29
    v_bfe_u32 v31, v1, 2, 1
    v_lshlrev_b32 v30, 3, v31
    v_bfe_u32 v31, v1, 3, 1
    v_lshl_add_u32 v30, v31, 2, v30
    v_bfe_u32 v31, v1, 0, 2
    v_lshl_add_u32 v30, v31, 0, v30
    v_and_b32 v28, 16, v1
    v_cmp_eq_u32 vcc, 0, v28
    s_nop 1
    v_cndmask_b32 v30, 16, v30, vcc
    v_mul_u32_u24 v28, 80, v30
    v_lshl_add_u32 v28, v32, 4, v28
    v_add_u32 v28, 147456, v28
    v_accvgpr_write_b32 a245, v28
    s_lshl_b32 s52, s45, 8
    s_lshl_b32 s88, s46, 6
    s_add_u32 s52, s52, s88
    v_bfe_u32 v31, v1, 2, 1
    v_lshlrev_b32 v28, 5, v31
    v_bfe_u32 v31, v1, 3, 2
    v_lshl_add_u32 v28, v31, 3, v28
    v_bfe_u32 v31, v1, 0, 2
    v_lshl_add_u32 v28, v31, 1, v28
    v_lshl_add_u32 v28, v32, 13, v28
    v_add_u32 v28, s52, v28
    v_accvgpr_write_b32 a246, v28
    s_mov_b32 s52, s86
    s_add_u32 s52, s52, 131072
    v_add_u32 v28, s52, v2
    v_accvgpr_write_b32 a247, v28
    v_lshrrev_b32 v31, 2, v1
    v_lshlrev_b32 v28, 10, v31
    v_bfe_u32 v31, v1, 0, 2
    v_lshl_add_u32 v28, v31, 4, v28
    v_add_u32 v28, 2048, v28
    v_accvgpr_write_b32 a248, v28
    v_bfe_u32 v31, v1, 0, 5
    v_lshlrev_b32 v28, 6, v31
    v_lshl_add_u32 v28, v32, 5, v28
    v_add_u32 v28, s52, v28
    v_add_u32 v28, 4096, v28
    v_accvgpr_write_b32 a249, v28
    v_lshlrev_b32 v28, 6, v32
    v_xor_b32 v28, v28, v2
    s_mul_i32 s52, s89, 4224
    s_add_u32 s52, s52, s86
    v_xor_b32 v28, s52, v28
    v_accvgpr_write_b32 a250, v28
    s_lshl_b32 s52, s46, 3
    v_lshrrev_b32 v31, 3, v1
    v_lshlrev_b32 v28, 0, v31
    v_add_u32 v28, s52, v28
    v_lshlrev_b32 v29, 10, v28
    v_bfe_u32 v31, v1, 0, 3
    v_lshl_add_u32 v29, v31, 4, v29
    v_accvgpr_write_b32 a251, v29
    v_bfe_u32 v31, v1, 0, 3
    v_lshlrev_b32 v29, 1, v31
    v_xor_b32 v28, v28, v29
    v_lshlrev_b32 v29, 4, v28
    v_bfe_u32 v31, v1, 1, 1
    v_lshl_add_u32 v29, v31, 9, v29
    v_bfe_u32 v31, v1, 0, 1
    v_lshl_add_u32 v29, v31, 11, v29
    v_bfe_u32 v31, v1, 2, 1
    v_lshl_add_u32 v29, v31, 12, v29
    v_accvgpr_write_b32 a252, v29
    s_mul_i32 s65, s45, 36864
    s_add_u32 s65, s65, 262144
    s_mov_b32 s64, s65
    s_mul_i32 s88, s44, 2304
    s_add_u32 s64, s64, s88
    s_lshl_b32 s66, s45, 7
    s_lshl_b32 s88, s44, 2
    s_add_u32 s66, s66, s88
    s_lshl_b32 s68, s44, 11
    s_lshl_b32 s88, s45, 7
    s_add_u32 s68, s68, s88
    s_lshl_b32 s67, s44, 11
    s_lshl_b32 s85, s44, 11
    s_lshl_b32 s88, s45, 2
    s_add_u32 s85, s85, s88
    s_lshl_b32 s69, s44, 17
    s_lshl_b32 s88, s46, 15
    s_add_u32 s69, s69, s88
    s_lshl_b32 s88, s45, 11
    s_add_u32 s69, s69, s88
    s_add_u32 s69, s69, 2097152
    s_lshl_b32 s76, s44, 14
    s_lshl_b32 s88, s46, 12
    s_add_u32 s76, s76, s88
    s_add_u32 s76, s76, 1048576
    s_mul_i32 s77, s44, 458752
    s_lshl_b32 s88, s45, 13
    s_add_u32 s77, s77, s88
    s_lshl_b32 s88, s46, 11
    s_add_u32 s77, s77, s88
    s_add_u32 s77, s77, 6291456
    s_mul_i32 s78, s44, 458752
    s_mul_i32 s88, s61, 57344
    s_add_u32 s78, s78, s88
    s_mul_i32 s88, s46, 14336
    s_add_u32 s78, s78, s88
    s_add_u32 s78, s78, 6291456
    s_lshl_b32 s52, s44, 2
    s_add_u32 s52, s52, s61
    s_lshl_b32 s88, s90, 1
    s_add_u32 s52, s52, s88
    s_lshl_b32 s53, s47, 1
    s_add_u32 s53, s53, s89
    s_lshl_b32 s70, s52, 15
    s_lshl_b32 s88, s89, 14
    s_add_u32 s70, s70, s88
    s_add_u32 s70, s70, 2097152
    s_lshl_b32 s73, s52, 15
    s_lshl_b32 s88, s53, 6
    s_add_u32 s73, s73, s88
    s_lshl_b32 s71, s52, 15
    s_lshl_b32 s88, s53, 11
    s_add_u32 s71, s71, s88
    s_add_u32 s71, s71, 4194304
    s_lshl_b32 s72, s52, 12
    s_lshl_b32 s88, s53, 8
    s_add_u32 s72, s72, s88
    s_add_u32 s72, s72, 1048576
    s_and_b32 s52, s44, 0
    s_and_b32 s53, s61, 0
    s_mov_b32 s53, s53
    s_lshl_b32 s88, s52, 1
    s_add_u32 s53, s53, s88
    s_lshr_b32 s50, s47, 1
    s_add_u32 s50, s50, s53
    s_and_b32 s50, s50, 3
    s_lshl_b32 s83, s50, 12
    s_lshl_b32 s79, s90, 17
    s_lshl_b32 s88, s50, 16
    s_add_u32 s79, s79, s88
    s_and_b32 s79, s79, 262143
    s_mov_b32 s50, s45
    s_lshl_b32 s88, s52, 1
    s_add_u32 s50, s50, s88
    s_and_b32 s50, s50, 3
    s_mul_i32 s80, s50, 458752
    s_lshl_b32 s51, s50, 1
    s_add_u32 s51, s51, s46
    s_and_b32 s87, s51, 7
    s_lshl_b32 s74, s44, 17
    s_lshl_b32 s88, s87, 12
    s_add_u32 s74, s74, s88
    s_add_u32 s74, s74, 4194304
    s_xor_b32 s87, s87, 4
    s_lshl_b32 s75, s44, 17
    s_lshl_b32 s88, s87, 12
    s_add_u32 s75, s75, s88
    s_add_u32 s75, s75, 4194304
    s_mov_b32 s50, s47
    s_lshl_b32 s88, s53, 1
    s_add_u32 s50, s50, s88
    s_add_u32 s51, s50, -7
    s_cselect_b32 s50, s51, s50
    s_lshl_b32 s81, s50, 15
    s_lshl_b32 s82, s50, 11
    s_sub_u32 s20, s20, 3072
    s_subb_u32 s21, s21, 0
    s_cmp_ge_u32 s45, 14
    s_cselect_b32 s22, 0, 1838080
    v_mov_b32 v112, 0
    v_mov_b32 v113, 0
    v_mov_b32 v114, 0
    v_mov_b32 v115, 0
    v_mov_b32 v116, 0
    v_mov_b32 v117, 0
    v_mov_b32 v118, 0
    v_mov_b32 v126, 0
    v_mov_b32 v127, 0
    s_waitcnt lgkmcnt(0)
    s_mul_i32 s36, s36, 0x9e3779b1
    s_add_u32 s36, s36, 0x7f4a7c15
    v_mov_b32 v121, s36
    s_add_u32 m0, s58, 8192
    s_nop 0
    buffer_load_dwordx4 v10, s[8:11], s49 offen lds
    buffer_load_dwordx4 v10, s[8:11], s49 offen offset:1024 lds
    s_add_u32 s49, s49, 196608
    s_cmp_eq_u32 s49, 1572864
    s_cmov_b32 s49, 0
    s_add_u32 m0, s57, 4096
    s_nop 0
    buffer_load_dwordx4 v6, s[4:7], s48 offen offset:0 lds
    buffer_load_dwordx4 v7, s[4:7], s48 offen offset:1024 lds
    buffer_load_dwordx4 v8, s[4:7], s48 offen offset:2048 lds
    buffer_load_dwordx4 v9, s[4:7], s48 offen offset:3072 lds
    s_add_u32 s48, s48, 128
    s_and_b32 s48, s48, 1023
    s_waitcnt vmcnt(6)
    s_barrier
    ds_read_b64_tr_b16 v[76:77], v72
    ds_read_b64_tr_b16 v[78:79], v72 offset:256
    ds_read_b128 v[128:131], v12 offset:0
    ds_read_b64_tr_b16 v[80:81], v16 offset:0
    ds_read_b64_tr_b16 v[82:83], v16 offset:256
    ds_read_b64_tr_b16 v[84:85], v16 offset:1024
    ds_read_b64_tr_b16 v[86:87], v16 offset:1280
    ds_read_b128 v[132:135], v13 offset:0
    ds_read_b64_tr_b16 a[128:129], v17 offset:0
    ds_read_b64_tr_b16 a[130:131], v17 offset:256
    ds_read_b64_tr_b16 a[132:133], v17 offset:1024
    ds_read_b64_tr_b16 a[134:135], v17 offset:1280
    ds_read_b128 v[136:139], v14 offset:0
    ds_read_b64_tr_b16 a[136:137], v18 offset:0
    ds_read_b64_tr_b16 a[138:139], v18 offset:256
    ds_read_b64_tr_b16 a[140:141], v18 offset:1024
    ds_read_b64_tr_b16 a[142:143], v18 offset:1280
    ds_read_b128 v[140:143], v15 offset:0
    ds_read_b64_tr_b16 a[144:145], v19 offset:0
    ds_read_b64_tr_b16 a[146:147], v19 offset:256
    ds_read_b64_tr_b16 a[148:149], v19 offset:1024
    ds_read_b64_tr_b16 a[150:151], v19 offset:1280
    s_add_u32 m0, s58, 16384
    s_nop 0
    buffer_load_dwordx4 v10, s[8:11], s49 offen lds
    buffer_load_dwordx4 v10, s[8:11], s49 offen offset:1024 lds
    s_add_u32 s49, s49, 196608
    s_cmp_eq_u32 s49, 1572864
    s_cmov_b32 s49, 0
    s_add_u32 m0, s57, 8192
    s_nop 0
    buffer_load_dwordx4 v6, s[4:7], s48 offen offset:0 lds
    buffer_load_dwordx4 v7, s[4:7], s48 offen offset:1024 lds
    buffer_load_dwordx4 v8, s[4:7], s48 offen offset:2048 lds
    buffer_load_dwordx4 v9, s[4:7], s48 offen offset:3072 lds
    s_add_u32 s48, s48, 128
    s_and_b32 s48, s48, 1023
    s_waitcnt lgkmcnt(15)
    v_cndmask_b32 v64, 0, v76, s[62:63]
    v_cndmask_b32 v68, v76, 0, s[62:63]
    v_cndmask_b32 v65, 0, v77, s[62:63]
    v_cndmask_b32 v69, v77, 0, s[62:63]
    v_cndmask_b32 v66, 0, v78, s[62:63]
    v_cndmask_b32 v70, v78, 0, s[62:63]
    v_cndmask_b32 v67, 0, v79, s[62:63]
    v_cndmask_b32 v71, v79, 0, s[62:63]
    v_accvgpr_write_b32 a224, v64
    v_accvgpr_write_b32 a225, v65
    v_accvgpr_write_b32 a226, v66
    v_accvgpr_write_b32 a227, v67
    v_accvgpr_write_b32 a228, v68
    v_accvgpr_write_b32 a229, v69
    v_accvgpr_write_b32 a230, v70
    v_accvgpr_write_b32 a231, v71
    s_waitcnt vmcnt(6)
    s_waitcnt lgkmcnt(0)
    s_barrier
    v_mfma_f32_32x32x16_bf16 v[32:47], v[80:83], v[128:131], 0
    ds_read_b128 v[144:147], v12 offset:4096
    s_add_u32 m0, s58, 24576
    ds_read_b64_tr_b16 v[88:89], v16 offset:8192
    buffer_load_dwordx4 v10, s[8:11], s49 offen lds
    v_mfma_f32_32x32x16_bf16 v[48:63], v[84:87], v[128:131], 0
    ds_read_b64_tr_b16 v[90:91], v16 offset:8448
    ds_read_b64_tr_b16 v[92:93], v16 offset:9216
    buffer_load_dwordx4 v10, s[8:11], s49 offen offset:1024 lds
    ds_read_b64_tr_b16 v[94:95], v16 offset:9472
    v_mfma_f32_32x32x16_bf16 v[32:47], a[128:131], v[132:135], v[32:47]
    s_add_u32 s49, s49, 196608
    ds_read_b128 v[148:151], v13 offset:4096
    ds_read_b64_tr_b16 a[152:153], v17 offset:8192
    s_cmp_eq_u32 s49, 1572864
    s_cmov_b32 s49, 0
    v_mfma_f32_32x32x16_bf16 v[48:63], a[132:135], v[132:135], v[48:63]
    ds_read_b64_tr_b16 a[154:155], v17 offset:8448
    ds_read_b64_tr_b16 a[156:157], v17 offset:9216
    ds_read_b64_tr_b16 a[158:159], v17 offset:9472
    s_add_u32 m0, s57, 12288
    v_mfma_f32_32x32x16_bf16 v[32:47], a[136:139], v[136:139], v[32:47]
    ds_read_b128 v[152:155], v14 offset:4096
    buffer_load_dwordx4 v6, s[4:7], s48 offen offset:0 lds
    ds_read_b64_tr_b16 a[160:161], v18 offset:8192
    ds_read_b64_tr_b16 a[162:163], v18 offset:8448
    v_mfma_f32_32x32x16_bf16 v[48:63], a[140:143], v[136:139], v[48:63]
    buffer_load_dwordx4 v7, s[4:7], s48 offen offset:1024 lds
    ds_read_b64_tr_b16 a[164:165], v18 offset:9216
    buffer_load_dwordx4 v8, s[4:7], s48 offen offset:2048 lds
    ds_read_b64_tr_b16 a[166:167], v18 offset:9472
    v_mfma_f32_32x32x16_bf16 v[32:47], a[144:147], v[140:143], v[32:47]
    ds_read_b128 v[156:159], v15 offset:4096
    buffer_load_dwordx4 v9, s[4:7], s48 offen offset:3072 lds
    ds_read_b64_tr_b16 a[168:169], v19 offset:8192
    s_add_u32 s48, s48, 128
    v_mfma_f32_32x32x16_bf16 v[48:63], a[148:151], v[140:143], v[48:63]
    ds_read_b64_tr_b16 a[170:171], v19 offset:8448
    ds_read_b64_tr_b16 a[172:173], v19 offset:9216
    s_and_b32 s48, s48, 1023
    ds_read_b64_tr_b16 a[174:175], v19 offset:9472
    v_dot2_f32_bf16 v116, v80, s54, v116
    v_dot2_f32_bf16 v117, v84, s54, v117
    v_dot2_f32_bf16 v116, v81, s54, v116
    v_dot2_f32_bf16 v117, v85, s54, v117
    v_dot2_f32_bf16 v116, v82, s54, v116
    v_dot2_f32_bf16 v117, v86, s54, v117
    v_dot2_f32_bf16 v116, v83, s54, v116
    v_dot2_f32_bf16 v117, v87, s54, v117
    v_dot2_f32_bf16 v113, v128, s54, v113
    v_dot2_f32_bf16 v115, v128, v128, v115
    v_dot2_f32_bf16 v112, v129, s54, v112
    v_dot2_f32_bf16 v114, v129, v129, v114
    v_dot2_f32_bf16 v113, v130, s54, v113
    v_dot2_f32_bf16 v115, v130, v130, v115
    v_dot2_f32_bf16 v112, v131, s54, v112
    v_dot2_f32_bf16 v114, v131, v131, v114
    v_dot2_f32_bf16 v113, v132, s54, v113
    v_dot2_f32_bf16 v115, v132, v132, v115
    v_dot2_f32_bf16 v112, v133, s54, v112
    v_dot2_f32_bf16 v114, v133, v133, v114
    v_dot2_f32_bf16 v113, v134, s54, v113
    v_dot2_f32_bf16 v115, v134, v134, v115
    v_dot2_f32_bf16 v112, v135, s54, v112
    v_dot2_f32_bf16 v114, v135, v135, v114
    v_dot2_f32_bf16 v113, v136, s54, v113
    v_dot2_f32_bf16 v115, v136, v136, v115
    v_dot2_f32_bf16 v112, v137, s54, v112
    v_dot2_f32_bf16 v114, v137, v137, v114
    v_dot2_f32_bf16 v113, v138, s54, v113
    v_dot2_f32_bf16 v115, v138, v138, v115
    v_dot2_f32_bf16 v112, v139, s54, v112
    v_dot2_f32_bf16 v114, v139, v139, v114
    v_dot2_f32_bf16 v113, v140, s54, v113
    v_dot2_f32_bf16 v115, v140, v140, v115
    v_dot2_f32_bf16 v112, v141, s54, v112
    v_dot2_f32_bf16 v114, v141, v141, v114
    v_dot2_f32_bf16 v113, v142, s54, v113
    v_dot2_f32_bf16 v115, v142, v142, v115
    v_dot2_f32_bf16 v112, v143, s54, v112
    v_dot2_f32_bf16 v114, v143, v143, v114
    s_waitcnt vmcnt(6)
    s_waitcnt lgkmcnt(0)
    s_barrier
    v_mfma_f32_32x32x16_bf16 v[32:47], v[88:91], v[144:147], v[32:47]
    ds_read_b128 v[160:163], v12 offset:8192
    s_add_u32 m0, s58, 32768
    ds_read_b64_tr_b16 v[80:81], v16 offset:16384
    buffer_load_dwordx4 v10, s[8:11], s49 offen lds
    v_mfma_f32_32x32x16_bf16 v[48:63], v[92:95], v[144:147], v[48:63]
    ds_read_b64_tr_b16 v[82:83], v16 offset:16640
    ds_read_b64_tr_b16 v[84:85], v16 offset:17408
    buffer_load_dwordx4 v10, s[8:11], s49 offen offset:1024 lds
    ds_read_b64_tr_b16 v[86:87], v16 offset:17664
    v_mfma_f32_32x32x16_bf16 v[32:47], a[152:155], v[148:151], v[32:47]
    s_add_u32 s49, s49, 196608
    ds_read_b128 v[164:167], v13 offset:8192
    ds_read_b64_tr_b16 a[128:129], v17 offset:16384
    s_cmp_eq_u32 s49, 1572864
    s_cmov_b32 s49, 0
    v_mfma_f32_32x32x16_bf16 v[48:63], a[156:159], v[148:151], v[48:63]
    ds_read_b64_tr_b16 a[130:131], v17 offset:16640
    ds_read_b64_tr_b16 a[132:133], v17 offset:17408
    ds_read_b64_tr_b16 a[134:135], v17 offset:17664
    s_add_u32 m0, s57, 0
    v_mfma_f32_32x32x16_bf16 v[32:47], a[160:163], v[152:155], v[32:47]
    ds_read_b128 v[168:171], v14 offset:8192
    buffer_load_dwordx4 v6, s[4:7], s48 offen offset:0 lds
    ds_read_b64_tr_b16 a[136:137], v18 offset:16384
    ds_read_b64_tr_b16 a[138:139], v18 offset:16640
    v_mfma_f32_32x32x16_bf16 v[48:63], a[164:167], v[152:155], v[48:63]
    buffer_load_dwordx4 v7, s[4:7], s48 offen offset:1024 lds
    ds_read_b64_tr_b16 a[140:141], v18 offset:17408
    buffer_load_dwordx4 v8, s[4:7], s48 offen offset:2048 lds
    ds_read_b64_tr_b16 a[142:143], v18 offset:17664
    v_mfma_f32_32x32x16_bf16 v[32:47], a[168:171], v[156:159], v[32:47]
    ds_read_b128 v[172:175], v15 offset:8192
    buffer_load_dwordx4 v9, s[4:7], s48 offen offset:3072 lds
    ds_read_b64_tr_b16 a[144:145], v19 offset:16384
    s_add_u32 s48, s48, 128
    v_mfma_f32_32x32x16_bf16 v[48:63], a[172:175], v[156:159], v[48:63]
    ds_read_b64_tr_b16 a[146:147], v19 offset:16640
    ds_read_b64_tr_b16 a[148:149], v19 offset:17408
    s_and_b32 s48, s48, 1023
    ds_read_b64_tr_b16 a[150:151], v19 offset:17664
    v_dot2_f32_bf16 v116, v88, s54, v116
    v_dot2_f32_bf16 v117, v92, s54, v117
    v_dot2_f32_bf16 v116, v89, s54, v116
    v_dot2_f32_bf16 v117, v93, s54, v117
    v_dot2_f32_bf16 v116, v90, s54, v116
    v_dot2_f32_bf16 v117, v94, s54, v117
    v_dot2_f32_bf16 v116, v91, s54, v116
    v_dot2_f32_bf16 v117, v95, s54, v117
    v_dot2_f32_bf16 v113, v144, s54, v113
    v_dot2_f32_bf16 v115, v144, v144, v115
    v_dot2_f32_bf16 v112, v145, s54, v112
    v_dot2_f32_bf16 v114, v145, v145, v114
    v_dot2_f32_bf16 v113, v146, s54, v113
    v_dot2_f32_bf16 v115, v146, v146, v115
    v_dot2_f32_bf16 v112, v147, s54, v112
    v_dot2_f32_bf16 v114, v147, v147, v114
    v_dot2_f32_bf16 v113, v148, s54, v113
    v_dot2_f32_bf16 v115, v148, v148, v115
    v_dot2_f32_bf16 v112, v149, s54, v112
    v_dot2_f32_bf16 v114, v149, v149, v114
    v_dot2_f32_bf16 v113, v150, s54, v113
    v_dot2_f32_bf16 v115, v150, v150, v115
    v_dot2_f32_bf16 v112, v151, s54, v112
    v_dot2_f32_bf16 v114, v151, v151, v114
    v_dot2_f32_bf16 v113, v152, s54, v113
    v_dot2_f32_bf16 v115, v152, v152, v115
    v_dot2_f32_bf16 v112, v153, s54, v112
    v_dot2_f32_bf16 v114, v153, v153, v114
    v_dot2_f32_bf16 v113, v154, s54, v113
    v_dot2_f32_bf16 v115, v154, v154, v115
    v_dot2_f32_bf16 v112, v155, s54, v112
    v_dot2_f32_bf16 v114, v155, v155, v114
    v_dot2_f32_bf16 v113, v156, s54, v113
    v_dot2_f32_bf16 v115, v156, v156, v115
    v_dot2_f32_bf16 v112, v157, s54, v112
    v_dot2_f32_bf16 v114, v157, v157, v114
    v_dot2_f32_bf16 v113, v158, s54, v113
    v_dot2_f32_bf16 v115, v158, v158, v115
    v_dot2_f32_bf16 v112, v159, s54, v112
    v_dot2_f32_bf16 v114, v159, v159, v114
    s_waitcnt vmcnt(6)
    s_waitcnt lgkmcnt(0)
    s_barrier
    v_mfma_f32_32x32x16_bf16 v[32:47], v[80:83], v[160:163], v[32:47]
    ds_read_b128 v[176:179], v12 offset:12288
    s_add_u32 m0, s58, 40960
    ds_read_b64_tr_b16 v[88:89], v16 offset:24576
    buffer_load_dwordx4 v10, s[8:11], s49 offen lds
    v_mfma_f32_32x32x16_bf16 v[48:63], v[84:87], v[160:163], v[48:63]
    ds_read_b64_tr_b16 v[90:91], v16 offset:24832
    ds_read_b64_tr_b16 v[92:93], v16 offset:25600
    buffer_load_dwordx4 v10, s[8:11], s49 offen offset:1024 lds
    ds_read_b64_tr_b16 v[94:95], v16 offset:25856
    v_mfma_f32_32x32x16_bf16 v[32:47], a[128:131], v[164:167], v[32:47]
    s_add_u32 s49, s49, 196608
    ds_read_b128 v[180:183], v13 offset:12288
    ds_read_b64_tr_b16 a[152:153], v17 offset:24576
    s_cmp_eq_u32 s49, 1572864
    s_cmov_b32 s49, 0
    v_mfma_f32_32x32x16_bf16 v[48:63], a[132:135], v[164:167], v[48:63]
    ds_read_b64_tr_b16 a[154:155], v17 offset:24832
    ds_read_b64_tr_b16 a[156:157], v17 offset:25600
    ds_read_b64_tr_b16 a[158:159], v17 offset:25856
    s_add_u32 m0, s57, 4096
    v_mfma_f32_32x32x16_bf16 v[32:47], a[136:139], v[168:171], v[32:47]
    ds_read_b128 v[184:187], v14 offset:12288
    buffer_load_dwordx4 v6, s[4:7], s48 offen offset:0 lds
    ds_read_b64_tr_b16 a[160:161], v18 offset:24576
    ds_read_b64_tr_b16 a[162:163], v18 offset:24832
    v_mfma_f32_32x32x16_bf16 v[48:63], a[140:143], v[168:171], v[48:63]
    buffer_load_dwordx4 v7, s[4:7], s48 offen offset:1024 lds
    ds_read_b64_tr_b16 a[164:165], v18 offset:25600
    buffer_load_dwordx4 v8, s[4:7], s48 offen offset:2048 lds
    ds_read_b64_tr_b16 a[166:167], v18 offset:25856
    v_mfma_f32_32x32x16_bf16 v[32:47], a[144:147], v[172:175], v[32:47]
    ds_read_b128 v[188:191], v15 offset:12288
    buffer_load_dwordx4 v9, s[4:7], s48 offen offset:3072 lds
    ds_read_b64_tr_b16 a[168:169], v19 offset:24576
    s_add_u32 s48, s48, 128
    v_mfma_f32_32x32x16_bf16 v[48:63], a[148:151], v[172:175], v[48:63]
    ds_read_b64_tr_b16 a[170:171], v19 offset:24832
    ds_read_b64_tr_b16 a[172:173], v19 offset:25600
    s_and_b32 s48, s48, 1023
    ds_read_b64_tr_b16 a[174:175], v19 offset:25856
    v_dot2_f32_bf16 v116, v80, s54, v116
    v_dot2_f32_bf16 v117, v84, s54, v117
    v_dot2_f32_bf16 v116, v81, s54, v116
    v_dot2_f32_bf16 v117, v85, s54, v117
    v_dot2_f32_bf16 v116, v82, s54, v116
    v_dot2_f32_bf16 v117, v86, s54, v117
    v_dot2_f32_bf16 v116, v83, s54, v116
    v_dot2_f32_bf16 v117, v87, s54, v117
    v_dot2_f32_bf16 v113, v160, s54, v113
    v_dot2_f32_bf16 v115, v160, v160, v115
    v_dot2_f32_bf16 v112, v161, s54, v112
    v_dot2_f32_bf16 v114, v161, v161, v114
    v_dot2_f32_bf16 v113, v162, s54, v113
    v_dot2_f32_bf16 v115, v162, v162, v115
    v_dot2_f32_bf16 v112, v163, s54, v112
    v_dot2_f32_bf16 v114, v163, v163, v114
    v_dot2_f32_bf16 v113, v164, s54, v113
    v_dot2_f32_bf16 v115, v164, v164, v115
    v_dot2_f32_bf16 v112, v165, s54, v112
    v_dot2_f32_bf16 v114, v165, v165, v114
    v_dot2_f32_bf16 v113, v166, s54, v113
    v_dot2_f32_bf16 v115, v166, v166, v115
    v_dot2_f32_bf16 v112, v167, s54, v112
    v_dot2_f32_bf16 v114, v167, v167, v114
    v_dot2_f32_bf16 v113, v168, s54, v113
    v_dot2_f32_bf16 v115, v168, v168, v115
    v_dot2_f32_bf16 v112, v169, s54, v112
    v_dot2_f32_bf16 v114, v169, v169, v114
    v_dot2_f32_bf16 v113, v170, s54, v113
    v_dot2_f32_bf16 v115, v170, v170, v115
    v_dot2_f32_bf16 v112, v171, s54, v112
    v_dot2_f32_bf16 v114, v171, v171, v114
    v_dot2_f32_bf16 v113, v172, s54, v113
    v_dot2_f32_bf16 v115, v172, v172, v115
    v_dot2_f32_bf16 v112, v173, s54, v112
    v_dot2_f32_bf16 v114, v173, v173, v114
    v_dot2_f32_bf16 v113, v174, s54, v113
    v_dot2_f32_bf16 v115, v174, v174, v115
    v_dot2_f32_bf16 v112, v175, s54, v112
    v_dot2_f32_bf16 v114, v175, v175, v114
    s_waitcnt vmcnt(6)
    s_waitcnt lgkmcnt(0)
    s_barrier
    v_mfma_f32_32x32x16_bf16 v[32:47], v[88:91], v[176:179], v[32:47]
    ds_read_b128 v[192:195], v12 offset:0
    s_add_u32 m0, s58, 49152
    ds_read_b64_tr_b16 v[80:81], v16 offset:32768
    buffer_load_dwordx4 v10, s[8:11], s49 offen lds
    v_mfma_f32_32x32x16_bf16 v[48:63], v[92:95], v[176:179], v[48:63]
    ds_read_b64_tr_b16 v[82:83], v16 offset:33024
    ds_read_b64_tr_b16 v[84:85], v16 offset:33792
    buffer_load_dwordx4 v10, s[8:11], s49 offen offset:1024 lds
    ds_read_b64_tr_b16 v[86:87], v16 offset:34048
    v_mfma_f32_32x32x16_bf16 v[32:47], a[152:155], v[180:183], v[32:47]
    s_add_u32 s49, s49, 196608
    ds_read_b128 v[196:199], v13 offset:0
    ds_read_b64_tr_b16 a[128:129], v17 offset:32768
    s_cmp_eq_u32 s49, 1572864
    s_cmov_b32 s49, 0
    v_mfma_f32_32x32x16_bf16 v[48:63], a[156:159], v[180:183], v[48:63]
    ds_read_b64_tr_b16 a[130:131], v17 offset:33024
    ds_read_b64_tr_b16 a[132:133], v17 offset:33792
    ds_read_b64_tr_b16 a[134:135], v17 offset:34048
    s_add_u32 m0, s57, 8192
    v_mfma_f32_32x32x16_bf16 v[32:47], a[160:163], v[184:187], v[32:47]
    ds_read_b128 v[200:203], v14 offset:0
    buffer_load_dwordx4 v6, s[4:7], s48 offen offset:0 lds
    ds_read_b64_tr_b16 a[136:137], v18 offset:32768
    ds_read_b64_tr_b16 a[138:139], v18 offset:33024
    v_mfma_f32_32x32x16_bf16 v[48:63], a[164:167], v[184:187], v[48:63]
    buffer_load_dwordx4 v7, s[4:7], s48 offen offset:1024 lds
    ds_read_b64_tr_b16 a[140:141], v18 offset:33792
    buffer_load_dwordx4 v8, s[4:7], s48 offen offset:2048 lds
    ds_read_b64_tr_b16 a[142:143], v18 offset:34048
    v_mfma_f32_32x32x16_bf16 v[32:47], a[168:171], v[188:191], v[32:47]
    ds_read_b128 v[204:207], v15 offset:0
    buffer_load_dwordx4 v9, s[4:7], s48 offen offset:3072 lds
    ds_read_b64_tr_b16 a[144:145], v19 offset:32768
    s_add_u32 s48, s48, 128
    v_mfma_f32_32x32x16_bf16 v[48:63], a[172:175], v[188:191], v[48:63]
    ds_read_b64_tr_b16 a[146:147], v19 offset:33024
    ds_read_b64_tr_b16 a[148:149], v19 offset:33792
    s_and_b32 s48, s48, 1023
    ds_read_b64_tr_b16 a[150:151], v19 offset:34048
    v_dot2_f32_bf16 v116, v88, s54, v116
    v_dot2_f32_bf16 v117, v92, s54, v117
    v_dot2_f32_bf16 v116, v89, s54, v116
    v_dot2_f32_bf16 v117, v93, s54, v117
    v_dot2_f32_bf16 v116, v90, s54, v116
    v_dot2_f32_bf16 v117, v94, s54, v117
    v_dot2_f32_bf16 v116, v91, s54, v116
    v_dot2_f32_bf16 v117, v95, s54, v117
    v_dot2_f32_bf16 v113, v176, s54, v113
    v_dot2_f32_bf16 v115, v176, v176, v115
    v_dot2_f32_bf16 v112, v177, s54, v112
    v_dot2_f32_bf16 v114, v177, v177, v114
    v_dot2_f32_bf16 v113, v178, s54, v113
    v_dot2_f32_bf16 v115, v178, v178, v115
    v_dot2_f32_bf16 v112, v179, s54, v112
    v_dot2_f32_bf16 v114, v179, v179, v114
    v_dot2_f32_bf16 v113, v180, s54, v113
    v_dot2_f32_bf16 v115, v180, v180, v115
    v_dot2_f32_bf16 v112, v181, s54, v112
    v_dot2_f32_bf16 v114, v181, v181, v114
    v_dot2_f32_bf16 v113, v182, s54, v113
    v_dot2_f32_bf16 v115, v182, v182, v115
    v_dot2_f32_bf16 v112, v183, s54, v112
    v_dot2_f32_bf16 v114, v183, v183, v114
    v_dot2_f32_bf16 v113, v184, s54, v113
    v_dot2_f32_bf16 v115, v184, v184, v115
    v_dot2_f32_bf16 v112, v185, s54, v112
    v_dot2_f32_bf16 v114, v185, v185, v114
    v_dot2_f32_bf16 v113, v186, s54, v113
    v_dot2_f32_bf16 v115, v186, v186, v115
    v_dot2_f32_bf16 v112, v187, s54, v112
    v_dot2_f32_bf16 v114, v187, v187, v114
    v_dot2_f32_bf16 v113, v188, s54, v113
    v_dot2_f32_bf16 v115, v188, v188, v115
    v_dot2_f32_bf16 v112, v189, s54, v112
    v_dot2_f32_bf16 v114, v189, v189, v114
    v_dot2_f32_bf16 v113, v190, s54, v113
    v_dot2_f32_bf16 v115, v190, v190, v115
    v_dot2_f32_bf16 v112, v191, s54, v112
    v_dot2_f32_bf16 v114, v191, v191, v114
    s_waitcnt vmcnt(6)
    s_waitcnt lgkmcnt(0)
    s_barrier
    v_mfma_f32_32x32x16_bf16 v[32:47], v[80:83], v[192:195], v[32:47]
    ds_read_b128 v[208:211], v12 offset:4096
    s_add_u32 m0, s58, 57344
    ds_read_b64_tr_b16 v[88:89], v16 offset:40960
    buffer_load_dwordx4 v10, s[8:11], s49 offen lds
    v_mfma_f32_32x32x16_bf16 v[48:63], v[84:87], v[192:195], v[48:63]
    ds_read_b64_tr_b16 v[90:91], v16 offset:41216
    ds_read_b64_tr_b16 v[92:93], v16 offset:41984
    buffer_load_dwordx4 v10, s[8:11], s49 offen offset:1024 lds
    ds_read_b64_tr_b16 v[94:95], v16 offset:42240
    v_mfma_f32_32x32x16_bf16 v[32:47], a[128:131], v[196:199], v[32:47]
    s_add_u32 s49, s49, 196608
    ds_read_b128 v[212:215], v13 offset:4096
    ds_read_b64_tr_b16 a[152:153], v17 offset:40960
    s_cmp_eq_u32 s49, 1572864
    s_cmov_b32 s49, 0
    v_mfma_f32_32x32x16_bf16 v[48:63], a[132:135], v[196:199], v[48:63]
    ds_read_b64_tr_b16 a[154:155], v17 offset:41216
    ds_read_b64_tr_b16 a[156:157], v17 offset:41984
    ds_read_b64_tr_b16 a[158:159], v17 offset:42240
    s_add_u32 m0, s57, 12288
    v_mfma_f32_32x32x16_bf16 v[32:47], a[136:139], v[200:203], v[32:47]
    ds_read_b128 v[216:219], v14 offset:4096
    buffer_load_dwordx4 v6, s[4:7], s48 offen offset:0 lds
    ds_read_b64_tr_b16 a[160:161], v18 offset:40960
    ds_read_b64_tr_b16 a[162:163], v18 offset:41216
    v_mfma_f32_32x32x16_bf16 v[48:63], a[140:143], v[200:203], v[48:63]
    buffer_load_dwordx4 v7, s[4:7], s48 offen offset:1024 lds
    ds_read_b64_tr_b16 a[164:165], v18 offset:41984
    buffer_load_dwordx4 v8, s[4:7], s48 offen offset:2048 lds
    ds_read_b64_tr_b16 a[166:167], v18 offset:42240
    v_mfma_f32_32x32x16_bf16 v[32:47], a[144:147], v[204:207], v[32:47]
    ds_read_b128 v[220:223], v15 offset:4096
    buffer_load_dwordx4 v9, s[4:7], s48 offen offset:3072 lds
    ds_read_b64_tr_b16 a[168:169], v19 offset:40960
    s_add_u32 s48, s48, 128
    v_mfma_f32_32x32x16_bf16 v[48:63], a[148:151], v[204:207], v[48:63]
    ds_read_b64_tr_b16 a[170:171], v19 offset:41216
    ds_read_b64_tr_b16 a[172:173], v19 offset:41984
    s_and_b32 s48, s48, 1023
    ds_read_b64_tr_b16 a[174:175], v19 offset:42240
    v_dot2_f32_bf16 v116, v80, s54, v116
    v_dot2_f32_bf16 v117, v84, s54, v117
    v_dot2_f32_bf16 v116, v81, s54, v116
    v_dot2_f32_bf16 v117, v85, s54, v117
    v_dot2_f32_bf16 v116, v82, s54, v116
    v_dot2_f32_bf16 v117, v86, s54, v117
    v_dot2_f32_bf16 v116, v83, s54, v116
    v_dot2_f32_bf16 v117, v87, s54, v117
    v_dot2_f32_bf16 v113, v192, s54, v113
    v_dot2_f32_bf16 v115, v192, v192, v115
    v_dot2_f32_bf16 v112, v193, s54, v112
    v_dot2_f32_bf16 v114, v193, v193, v114
    v_dot2_f32_bf16 v113, v194, s54, v113
    v_dot2_f32_bf16 v115, v194, v194, v115
    v_dot2_f32_bf16 v112, v195, s54, v112
    v_dot2_f32_bf16 v114, v195, v195, v114
    v_dot2_f32_bf16 v113, v196, s54, v113
    v_dot2_f32_bf16 v115, v196, v196, v115
    v_dot2_f32_bf16 v112, v197, s54, v112
    v_dot2_f32_bf16 v114, v197, v197, v114
    v_dot2_f32_bf16 v113, v198, s54, v113
    v_dot2_f32_bf16 v115, v198, v198, v115
    v_dot2_f32_bf16 v112, v199, s54, v112
    v_dot2_f32_bf16 v114, v199, v199, v114
    v_dot2_f32_bf16 v113, v200, s54, v113
    v_dot2_f32_bf16 v115, v200, v200, v115
    v_dot2_f32_bf16 v112, v201, s54, v112
    v_dot2_f32_bf16 v114, v201, v201, v114
    v_dot2_f32_bf16 v113, v202, s54, v113
    v_dot2_f32_bf16 v115, v202, v202, v115
    v_dot2_f32_bf16 v112, v203, s54, v112
    v_dot2_f32_bf16 v114, v203, v203, v114
    v_dot2_f32_bf16 v113, v204, s54, v113
    v_dot2_f32_bf16 v115, v204, v204, v115
    v_dot2_f32_bf16 v112, v205, s54, v112
    v_dot2_f32_bf16 v114, v205, v205, v114
    v_dot2_f32_bf16 v113, v206, s54, v113
    v_dot2_f32_bf16 v115, v206, v206, v115
    v_dot2_f32_bf16 v112, v207, s54, v112
    v_dot2_f32_bf16 v114, v207, v207, v114
    s_waitcnt vmcnt(6)
    s_waitcnt lgkmcnt(0)
    s_barrier
    v_mfma_f32_32x32x16_bf16 v[32:47], v[88:91], v[208:211], v[32:47]
    ds_read_b128 v[224:227], v12 offset:8192
    s_add_u32 m0, s58, 131072
    ds_read_b64_tr_b16 v[80:81], v16 offset:49152
    ds_read_b64_tr_b16 v[82:83], v16 offset:49408
    v_mfma_f32_32x32x16_bf16 v[48:63], v[92:95], v[208:211], v[48:63]
    buffer_load_dwordx4 v11, s[8:11], s49 offen lds
    ds_read_b64_tr_b16 v[84:85], v16 offset:50176
    ds_read_b64_tr_b16 v[86:87], v16 offset:50432
    s_add_u32 s49, s49, 196608
    v_mfma_f32_32x32x16_bf16 v[32:47], a[152:155], v[212:215], v[32:47]
    ds_read_b128 v[228:231], v13 offset:8192
    ds_read_b64_tr_b16 a[128:129], v17 offset:49152
    s_cmp_eq_u32 s49, 1572864
    s_cmov_b32 s49, 0
    v_mfma_f32_32x32x16_bf16 v[48:63], a[156:159], v[212:215], v[48:63]
    ds_read_b64_tr_b16 a[130:131], v17 offset:49408
    ds_read_b64_tr_b16 a[132:133], v17 offset:50176
    ds_read_b64_tr_b16 a[134:135], v17 offset:50432
    v_mfma_f32_32x32x16_bf16 v[32:47], a[160:163], v[216:219], v[32:47]
    ds_read_b128 v[232:235], v14 offset:8192
    s_add_u32 m0, s58, 132096
    ds_read_b64_tr_b16 a[136:137], v18 offset:49152
    ds_read_b64_tr_b16 a[138:139], v18 offset:49408
    v_mfma_f32_32x32x16_bf16 v[48:63], a[164:167], v[216:219], v[48:63]
    buffer_load_dwordx4 v11, s[8:11], s49 offen lds
    ds_read_b64_tr_b16 a[140:141], v18 offset:50176
    ds_read_b64_tr_b16 a[142:143], v18 offset:50432
    s_add_u32 s49, s49, 196608
    v_mfma_f32_32x32x16_bf16 v[32:47], a[168:171], v[220:223], v[32:47]
    ds_read_b128 v[236:239], v15 offset:8192
    ds_read_b64_tr_b16 a[144:145], v19 offset:49152
    s_cmp_eq_u32 s49, 1572864
    s_cmov_b32 s49, 0
    v_mfma_f32_32x32x16_bf16 v[48:63], a[172:175], v[220:223], v[48:63]
    ds_read_b64_tr_b16 a[146:147], v19 offset:49408
    ds_read_b64_tr_b16 a[148:149], v19 offset:50176
    ds_read_b64_tr_b16 a[150:151], v19 offset:50432
    v_dot2_f32_bf16 v116, v88, s54, v116
    v_dot2_f32_bf16 v117, v92, s54, v117
    v_dot2_f32_bf16 v116, v89, s54, v116
    v_dot2_f32_bf16 v117, v93, s54, v117
    v_dot2_f32_bf16 v116, v90, s54, v116
    v_dot2_f32_bf16 v117, v94, s54, v117
    v_dot2_f32_bf16 v116, v91, s54, v116
    v_dot2_f32_bf16 v117, v95, s54, v117
    v_dot2_f32_bf16 v113, v208, s54, v113
    v_dot2_f32_bf16 v115, v208, v208, v115
    v_dot2_f32_bf16 v112, v209, s54, v112
    v_dot2_f32_bf16 v114, v209, v209, v114
    v_dot2_f32_bf16 v113, v210, s54, v113
    v_dot2_f32_bf16 v115, v210, v210, v115
    v_dot2_f32_bf16 v112, v211, s54, v112
    v_dot2_f32_bf16 v114, v211, v211, v114
    v_dot2_f32_bf16 v113, v212, s54, v113
    v_dot2_f32_bf16 v115, v212, v212, v115
    v_dot2_f32_bf16 v112, v213, s54, v112
    v_dot2_f32_bf16 v114, v213, v213, v114
    v_dot2_f32_bf16 v113, v214, s54, v113
    v_dot2_f32_bf16 v115, v214, v214, v115
    v_dot2_f32_bf16 v112, v215, s54, v112
    v_dot2_f32_bf16 v114, v215, v215, v114
    v_dot2_f32_bf16 v113, v216, s54, v113
    v_dot2_f32_bf16 v115, v216, v216, v115
    v_dot2_f32_bf16 v112, v217, s54, v112
    v_dot2_f32_bf16 v114, v217, v217, v114
    v_dot2_f32_bf16 v113, v218, s54, v113
    v_dot2_f32_bf16 v115, v218, v218, v115
    v_dot2_f32_bf16 v112, v219, s54, v112
    v_dot2_f32_bf16 v114, v219, v219, v114
    v_dot2_f32_bf16 v113, v220, s54, v113
    v_dot2_f32_bf16 v115, v220, v220, v115
    v_dot2_f32_bf16 v112, v221, s54, v112
    v_dot2_f32_bf16 v114, v221, v221, v114
    v_dot2_f32_bf16 v113, v222, s54, v113
    v_dot2_f32_bf16 v115, v222, v222, v115
    v_dot2_f32_bf16 v112, v223, s54, v112
    v_dot2_f32_bf16 v114, v223, v223, v114
    s_waitcnt vmcnt(2)
    s_waitcnt lgkmcnt(0)
    s_barrier
    v_mfma_f32_32x32x16_bf16 v[32:47], v[80:83], v[224:227], v[32:47]
    ds_read_b128 v[240:243], v12 offset:12288
    s_add_u32 m0, s58, 139264
    ds_read_b64_tr_b16 v[88:89], v16 offset:57344
    buffer_load_dwordx4 v11, s[8:11], s49 offen lds
    v_mfma_f32_32x32x16_bf16 v[48:63], v[84:87], v[224:227], v[48:63]
    ds_read_b64_tr_b16 v[90:91], v16 offset:57600
    s_add_u32 s49, s49, 196608
    ds_read_b64_tr_b16 v[92:93], v16 offset:58368
    ds_read_b64_tr_b16 v[94:95], v16 offset:58624
    v_mfma_f32_32x32x16_bf16 v[32:47], a[128:131], v[228:231], v[32:47]
    s_cmp_eq_u32 s49, 1572864
    s_cmov_b32 s49, 0
    ds_read_b128 v[244:247], v13 offset:12288
    ds_read_b64_tr_b16 a[152:153], v17 offset:57344
    s_add_u32 m0, s58, 140288
    v_mfma_f32_32x32x16_bf16 v[48:63], a[132:135], v[228:231], v[48:63]
    ds_read_b64_tr_b16 a[154:155], v17 offset:57600
    ds_read_b64_tr_b16 a[156:157], v17 offset:58368
    buffer_load_dwordx4 v11, s[8:11], s49 offen lds
    ds_read_b64_tr_b16 a[158:159], v17 offset:58624
    s_add_u32 s49, s49, 196608
    v_mfma_f32_32x32x16_bf16 v[32:47], a[136:139], v[232:235], v[32:47]
    ds_read_b128 v[248:251], v14 offset:12288
    s_cmp_eq_u32 s49, 1572864
    s_cmov_b32 s49, 0
    ds_read_b64_tr_b16 a[160:161], v18 offset:57344
    v_mfma_f32_32x32x16_bf16 v[48:63], a[140:143], v[232:235], v[48:63]
    ds_read_b64_tr_b16 a[162:163], v18 offset:57600
    ds_read_b64_tr_b16 a[164:165], v18 offset:58368
    s_add_u32 m0, s58, 147456
    ds_read_b64_tr_b16 a[166:167], v18 offset:58624
    v_mfma_f32_32x32x16_bf16 v[32:47], a[144:147], v[236:239], v[32:47]
    buffer_load_dwordx4 v11, s[8:11], s49 offen lds
    ds_read_b128 v[252:255], v15 offset:12288
    ds_read_b64_tr_b16 a[168:169], v19 offset:57344
    s_add_u32 s49, s49, 196608
    ds_read_b64_tr_b16 a[170:171], v19 offset:57600
    v_mfma_f32_32x32x16_bf16 v[48:63], a[148:151], v[236:239], v[48:63]
    s_cmp_eq_u32 s49, 1572864
    s_cmov_b32 s49, 0
    ds_read_b64_tr_b16 a[172:173], v19 offset:58368
    ds_read_b64_tr_b16 a[174:175], v19 offset:58624
    v_dot2_f32_bf16 v116, v80, s54, v116
    v_dot2_f32_bf16 v117, v84, s54, v117
    v_dot2_f32_bf16 v116, v81, s54, v116
    v_dot2_f32_bf16 v117, v85, s54, v117
    v_dot2_f32_bf16 v116, v82, s54, v116
    v_dot2_f32_bf16 v117, v86, s54, v117
    v_dot2_f32_bf16 v116, v83, s54, v116
    v_dot2_f32_bf16 v117, v87, s54, v117
    v_dot2_f32_bf16 v113, v224, s54, v113
    v_dot2_f32_bf16 v115, v224, v224, v115
    v_dot2_f32_bf16 v112, v225, s54, v112
    v_dot2_f32_bf16 v114, v225, v225, v114
    v_dot2_f32_bf16 v113, v226, s54, v113
    v_dot2_f32_bf16 v115, v226, v226, v115
    v_dot2_f32_bf16 v112, v227, s54, v112
    v_dot2_f32_bf16 v114, v227, v227, v114
    v_dot2_f32_bf16 v113, v228, s54, v113
    v_dot2_f32_bf16 v115, v228, v228, v115
    v_dot2_f32_bf16 v112, v229, s54, v112
    v_dot2_f32_bf16 v114, v229, v229, v114
    v_dot2_f32_bf16 v113, v230, s54, v113
    v_dot2_f32_bf16 v115, v230, v230, v115
    v_dot2_f32_bf16 v112, v231, s54, v112
    v_dot2_f32_bf16 v114, v231, v231, v114
    v_dot2_f32_bf16 v113, v232, s54, v113
    v_dot2_f32_bf16 v115, v232, v232, v115
    v_dot2_f32_bf16 v112, v233, s54, v112
    v_dot2_f32_bf16 v114, v233, v233, v114
    v_dot2_f32_bf16 v113, v234, s54, v113
    v_dot2_f32_bf16 v115, v234, v234, v115
    v_dot2_f32_bf16 v112, v235, s54, v112
    v_dot2_f32_bf16 v114, v235, v235, v114
    v_dot2_f32_bf16 v113, v236, s54, v113
    v_dot2_f32_bf16 v115, v236, v236, v115
    v_dot2_f32_bf16 v112, v237, s54, v112
    v_dot2_f32_bf16 v114, v237, v237, v114
    v_dot2_f32_bf16 v113, v238, s54, v113
    v_dot2_f32_bf16 v115, v238, v238, v115
    v_dot2_f32_bf16 v112, v239, s54, v112
    v_dot2_f32_bf16 v114, v239, v239, v114
    s_waitcnt lgkmcnt(15)
    v_dot2_f32_bf16 v116, v88, s54, v116
    v_dot2_f32_bf16 v117, v92, s54, v117
    v_dot2_f32_bf16 v116, v89, s54, v116
    v_dot2_f32_bf16 v117, v93, s54, v117
    v_dot2_f32_bf16 v116, v90, s54, v116
    v_dot2_f32_bf16 v117, v94, s54, v117
    v_dot2_f32_bf16 v116, v91, s54, v116
    v_dot2_f32_bf16 v117, v95, s54, v117
    v_lshlrev_b32 v28, 3, v0
    s_nop 1
    ds_write_b64 v28, v[116:117] offset:24576
    v_dot2_f32_bf16 v113, v240, s54, v113
    v_dot2_f32_bf16 v115, v240, v240, v115
    v_dot2_f32_bf16 v112, v241, s54, v112
    v_dot2_f32_bf16 v114, v241, v241, v114
    v_dot2_f32_bf16 v113, v242, s54, v113
    v_dot2_f32_bf16 v115, v242, v242, v115
    v_dot2_f32_bf16 v112, v243, s54, v112
    v_dot2_f32_bf16 v114, v243, v243, v114
    s_waitcnt lgkmcnt(15)
    v_dot2_f32_bf16 v113, v244, s54, v113
    v_dot2_f32_bf16 v115, v244, v244, v115
    v_dot2_f32_bf16 v112, v245, s54, v112
    v_dot2_f32_bf16 v114, v245, v245, v114
    v_dot2_f32_bf16 v113, v246, s54, v113
    v_dot2_f32_bf16 v115, v246, v246, v115
    v_dot2_f32_bf16 v112, v247, s54, v112
    v_dot2_f32_bf16 v114, v247, v247, v114
    s_waitcnt lgkmcnt(10)
    v_dot2_f32_bf16 v113, v248, s54, v113
    v_dot2_f32_bf16 v115, v248, v248, v115
    v_dot2_f32_bf16 v112, v249, s54, v112
    v_dot2_f32_bf16 v114, v249, v249, v114
    v_dot2_f32_bf16 v113, v250, s54, v113
    v_dot2_f32_bf16 v115, v250, v250, v115
    v_dot2_f32_bf16 v112, v251, s54, v112
    v_dot2_f32_bf16 v114, v251, v251, v114
    s_waitcnt lgkmcnt(5)
    v_dot2_f32_bf16 v113, v252, s54, v113
    v_dot2_f32_bf16 v115, v252, v252, v115
    v_dot2_f32_bf16 v112, v253, s54, v112
    v_dot2_f32_bf16 v114, v253, v253, v114
    v_dot2_f32_bf16 v113, v254, s54, v113
    v_dot2_f32_bf16 v115, v254, v254, v115
    v_dot2_f32_bf16 v112, v255, s54, v112
    v_dot2_f32_bf16 v114, v255, v255, v114
    v_lshlrev_b32 v28, 3, v1
    s_waitcnt lgkmcnt(0)
    s_barrier
    ds_read_b64 v[64:65], v28 offset:24576
    ds_read_b64 v[66:67], v28 offset:25088
    ds_read_b64 v[68:69], v28 offset:25600
    ds_read_b64 v[70:71], v28 offset:26112
    v_mfma_f32_32x32x16_bf16 v[32:47], v[88:91], v[240:243], v[32:47]
    v_add_f32 v112, v112, v113
    s_waitcnt lgkmcnt(1)
    v_add_f32 v64, v64, v68
    v_add_f32 v114, v114, v115
    v_add_f32 v65, v65, v69
    v_mfma_f32_32x32x16_bf16 v[32:47], a[152:155], v[244:247], v[32:47]
    v_permlane32_swap_b32 v112, v114
    s_waitcnt lgkmcnt(0)
    v_add_f32 v66, v66, v70
    v_add_f32 v67, v67, v71
    v_add_f32 v112, v112, v114
    v_add_f32 v116, v64, v66
    v_mfma_f32_32x32x16_bf16 v[32:47], a[160:163], v[248:251], v[32:47]
    v_mov_b32 v114, v112
    v_add_f32 v117, v65, v67
    s_nop 0
    v_permlane32_swap_b32 v112, v114
    v_cvt_pk_bf16_f32 v72, v116, v116
    v_mfma_f32_32x32x16_bf16 v[32:47], a[168:171], v[252:255], v[32:47]
    v_mul_f32 v119, 0x3b000000, v112
    v_and_b32 v29, 0xffff0000, v72
    v_mul_f32 v114, 0x3b000000, v114
    v_sub_f32 v30, v116, v29
    v_fma_f32 v114, -v119, v119, v114
    v_mfma_f32_32x32x16_bf16 v[48:63], v[92:95], v[240:243], v[48:63]
    v_cvt_pk_bf16_f32 v73, v30, 0
    v_max_f32 v114, 0, v114
    v_mov_b32 v74, 0
    v_add_f32 v114, 0x3727c5ac, v114
    v_mfma_f32_32x32x16_bf16 v[48:63], a[156:159], v[244:247], v[48:63]
    v_mov_b32 v75, 0
    v_rsq_f32 v120, v114
    v_cvt_pk_bf16_f32 v76, v117, v117
    v_sub_f32 v112, 0, v119
    v_mfma_f32_32x32x16_bf16 v[48:63], a[164:167], v[248:251], v[48:63]
    v_and_b32 v29, 0xffff0000, v76
    v_cvt_pk_bf16_f32 v28, v112, v112
    v_sub_f32 v30, v117, v29
    v_and_b32 v113, 0xffff0000, v28
    v_cvt_pk_bf16_f32 v77, v30, 0
    v_mfma_f32_32x32x16_bf16 v[48:63], a[172:175], v[252:255], v[48:63]
    v_sub_f32 v115, v112, v113
    v_mov_b32 v78, 0
    v_cvt_pk_bf16_f32 v124, v113, v115
    v_mov_b32 v79, 0
    v_cvt_pk_bf16_f32 v125, v113, 0
    s_nop 1
    v_mfma_f32_32x32x16_bf16 v[32:47], v[72:75], v[124:127], v[32:47]
    v_mfma_f32_32x32x16_bf16 v[48:63], v[76:79], v[124:127], v[48:63]
    s_add_u32 m0, s58, 148480
    s_nop 0
    buffer_load_dwordx4 v11, s[8:11], s49 offen lds
    s_add_u32 s49, s49, 196608
    s_cmp_eq_u32 s49, 1572864
    s_cmov_b32 s49, 0
    s_add_u32 m0, s58, 155648
    s_nop 0
    buffer_load_dwordx4 v11, s[8:11], s49 offen lds
    s_add_u32 s49, s49, 196608
    s_cmp_eq_u32 s49, 1572864
    s_cmov_b32 s49, 0
    s_add_u32 m0, s58, 156672
    s_nop 0
    buffer_load_dwordx4 v11, s[8:11], s49 offen lds
    s_add_u32 s49, s49, 196608
    s_cmp_eq_u32 s49, 1572864
    s_cmov_b32 s49, 0
    v_lshlrev_b32 v10, 7, v1
    s_cmp_lg_u32 s46, 1
    s_cbranch_scc1 L_nw1
    s_mul_i32 s52, s2, 7168
    v_lshlrev_b32 v28, 7, v1
    s_mov_b32 exec_lo, 0xffffffff
    s_mov_b32 exec_hi, 0xffffff
    buffer_load_dword v30, v28, s[92:95], s52 offen
    s_mov_b64 exec, -1
L_nw1:
    s_cmp_lg_u32 s46, 2
    s_cbranch_scc1 L_nw2
    s_mul_i32 s52, s2, 7168
    v_lshlrev_b32 v28, 7, v1
    s_mov_b32 exec_lo, 0xffffffff
    s_mov_b32 exec_hi, 0xffffff
    buffer_load_dword v30, v28, s[28:31], s52 offen
    s_mov_b64 exec, -1
L_nw2:
    v_lshlrev_b32 v11, 15, v1
    v_lshlrev_b32 v31, 7, v1
    v_add_u32 v31, 97664, v31
    v_cmp_lt_u32 vcc, 5, v1
    s_nop 1
    v_cndmask_b32 v11, v11, v31, vcc
    v_writelane_b32 v11, s37, 8
    s_cmp_eq_u32 s46, 0
    s_cselect_b32 s52, s68, s67
    s_cselect_b32 exec_lo, 1, 0x1fe
    s_mov_b32 exec_hi, 0
    s_cmp_gt_u32 s46, 1
    s_cbranch_scc1 L_nowfl
    buffer_load_dword v11, v11, s[40:43], s52 offen sc1
L_nowfl:
    s_mov_b64 exec, -1
    v_accvgpr_read_b32 v6, a235
    v_add_u32 v7, 7168, v6
    v_add_u32 v8, 14336, v6
    v_add_u32 v9, 21504, v6
    v_mul_f32 v122, 0x3fb8aa3b, v120
    v_mul_f32 v123, 0xbfb8aa3b, v120
    v_cvt_pk_bf16_f32 v80, v32, v33
    v_cvt_pk_bf16_f32 v81, v34, v35
    v_cvt_pk_bf16_f32 v82, v36, v37
    v_cvt_pk_bf16_f32 v83, v38, v39
    v_cvt_pk_bf16_f32 v84, v40, v41
    v_cvt_pk_bf16_f32 v85, v42, v43
    v_cvt_pk_bf16_f32 v86, v44, v45
    v_cvt_pk_bf16_f32 v87, v46, v47
    v_mfma_f32_32x32x16_bf16 v[32:47], a[224:227], v[80:83], 0
    s_nop 0
    v_mfma_f32_32x32x16_bf16 v[32:47], a[228:231], v[84:87], v[32:47]
    v_mul_f32 v48, v48, v120
    v_mul_f32 v49, v49, v120
    v_mul_f32 v50, v50, v120
    v_mul_f32 v51, v51, v120
    v_mul_f32 v52, v52, v120
    v_mul_f32 v53, v53, v120
    v_mul_f32 v54, v54, v120
    v_mul_f32 v55, v55, v120
    v_pk_mul_f32 v[56:57], v[56:57], v[120:121] op_sel_hi:[1,0]
    v_pk_mul_f32 v[58:59], v[58:59], v[120:121] op_sel_hi:[1,0]
    v_pk_mul_f32 v[60:61], v[60:61], v[120:121] op_sel_hi:[1,0]
    v_pk_mul_f32 v[62:63], v[62:63], v[120:121] op_sel_hi:[1,0]
    v_cvt_pk_bf16_f32 v64, v48, v49
    v_cvt_pk_bf16_f32 v65, v50, v51
    v_cvt_pk_bf16_f32 v66, v52, v53
    v_cvt_pk_bf16_f32 v67, v54, v55
    v_cvt_pk_bf16_f32 v68, v56, v57
    v_cvt_pk_bf16_f32 v69, v58, v59
    v_cvt_pk_bf16_f32 v70, v60, v61
    v_cvt_pk_bf16_f32 v71, v62, v63
    ds_write_b64 v20, v[64:65] offset:16384
    ds_write_b64 v21, v[66:67] offset:16384
    ds_write_b64 v22, v[68:69] offset:16384
    ds_write_b64 v23, v[70:71] offset:16384
    v_max3_f32 v72, v32, v33, v34
    v_min3_f32 v74, v32, v33, v34
    v_max3_f32 v73, v35, v36, v37
    v_min3_f32 v75, v35, v36, v37
    v_max3_f32 v72, v72, v38, v39
    v_min3_f32 v74, v74, v38, v39
    v_max3_f32 v73, v73, v40, v41
    v_min3_f32 v75, v75, v40, v41
    v_max3_f32 v72, v72, v42, v43
    v_min3_f32 v74, v74, v42, v43
    v_max3_f32 v73, v73, v44, v45
    v_min3_f32 v75, v75, v44, v45
    v_max3_f32 v72, v72, v46, v47
    v_min3_f32 v74, v74, v46, v47
    v_max_f32 v72, v72, v73
    v_min_f32 v74, v74, v75
    v_mul_f32 v72, v72, v123
    v_mul_f32 v74, v74, v122
    v_pk_fma_f32 v[80:81], v[32:33], v[122:123], v[72:73] op_sel_hi:[1,0,0]
    v_pk_fma_f32 v[96:97], v[32:33], v[122:123], v[74:75] op_sel:[0,1,0] op_sel_hi:[1,1,0]
    v_pk_fma_f32 v[82:83], v[34:35], v[122:123], v[72:73] op_sel_hi:[1,0,0]
    v_pk_fma_f32 v[98:99], v[34:35], v[122:123], v[74:75] op_sel:[0,1,0] op_sel_hi:[1,1,0]
    v_pk_fma_f32 v[84:85], v[36:37], v[122:123], v[72:73] op_sel_hi:[1,0,0]
    v_pk_fma_f32 v[100:101], v[36:37], v[122:123], v[74:75] op_sel:[0,1,0] op_sel_hi:[1,1,0]
    v_pk_fma_f32 v[86:87], v[38:39], v[122:123], v[72:73] op_sel_hi:[1,0,0]
    v_pk_fma_f32 v[102:103], v[38:39], v[122:123], v[74:75] op_sel:[0,1,0] op_sel_hi:[1,1,0]
    v_pk_fma_f32 v[88:89], v[40:41], v[122:123], v[72:73] op_sel_hi:[1,0,0]
    v_pk_fma_f32 v[104:105], v[40:41], v[122:123], v[74:75] op_sel:[0,1,0] op_sel_hi:[1,1,0]
    v_pk_fma_f32 v[90:91], v[42:43], v[122:123], v[72:73] op_sel_hi:[1,0,0]
    v_pk_fma_f32 v[106:107], v[42:43], v[122:123], v[74:75] op_sel:[0,1,0] op_sel_hi:[1,1,0]
    v_pk_fma_f32 v[92:93], v[44:45], v[122:123], v[72:73] op_sel_hi:[1,0,0]
    v_pk_fma_f32 v[108:109], v[44:45], v[122:123], v[74:75] op_sel:[0,1,0] op_sel_hi:[1,1,0]
    v_pk_fma_f32 v[94:95], v[46:47], v[122:123], v[72:73] op_sel_hi:[1,0,0]
    v_pk_fma_f32 v[110:111], v[46:47], v[122:123], v[74:75] op_sel:[0,1,0] op_sel_hi:[1,1,0]
    v_exp_f32 v80, v80
    s_add_u32 m0, s57, 0
    v_exp_f32 v81, v81
    v_exp_f32 v82, v82
    v_exp_f32 v83, v83
    v_exp_f32 v84, v84
    buffer_load_dwordx4 v6, s[16:19], s79 offen offset:0 lds
    v_exp_f32 v85, v85
    v_exp_f32 v86, v86
    v_exp_f32 v87, v87
    v_exp_f32 v88, v88
    v_exp_f32 v89, v89
    buffer_load_dwordx4 v7, s[16:19], s79 offen offset:1024 lds
    v_exp_f32 v90, v90
    v_exp_f32 v91, v91
    v_exp_f32 v92, v92
    v_exp_f32 v93, v93
    buffer_load_dwordx4 v8, s[16:19], s79 offen offset:2048 lds
    v_exp_f32 v94, v94
    v_exp_f32 v95, v95
    v_exp_f32 v96, v96
    v_exp_f32 v97, v97
    v_exp_f32 v98, v98
    buffer_load_dwordx4 v9, s[16:19], s79 offen offset:3072 lds
    v_exp_f32 v99, v99
    v_exp_f32 v100, v100
    v_exp_f32 v101, v101
    v_exp_f32 v102, v102
    s_add_u32 s79, s79, 32768
    v_exp_f32 v103, v103
    v_exp_f32 v104, v104
    v_exp_f32 v105, v105
    v_exp_f32 v106, v106
    v_exp_f32 v107, v107
    s_and_b32 s79, s79, 262143
    v_exp_f32 v108, v108
    v_exp_f32 v109, v109
    v_exp_f32 v110, v110
    v_exp_f32 v111, v111
    v_pk_add_f32 v[76:77], v[80:81], v[82:83]
    v_pk_add_f32 v[78:79], v[96:97], v[98:99]
    v_pk_add_f32 v[76:77], v[76:77], v[84:85]
    v_pk_add_f32 v[78:79], v[78:79], v[100:101]
    v_pk_add_f32 v[76:77], v[76:77], v[86:87]
    v_pk_add_f32 v[78:79], v[78:79], v[102:103]
    v_pk_add_f32 v[76:77], v[76:77], v[88:89]
    v_pk_add_f32 v[78:79], v[78:79], v[104:105]
    v_pk_add_f32 v[76:77], v[76:77], v[90:91]
    v_pk_add_f32 v[78:79], v[78:79], v[106:107]
    v_pk_add_f32 v[76:77], v[76:77], v[92:93]
    v_pk_add_f32 v[78:79], v[78:79], v[108:109]
    v_pk_add_f32 v[76:77], v[76:77], v[94:95]
    v_pk_add_f32 v[78:79], v[78:79], v[110:111]
    v_add_f32 v76, v76, v77
    v_add_f32 v78, v78, v79
    v_rcp_f32 v76, v76
    v_rcp_f32 v78, v78
    v_pk_mul_f32 v[80:81], v[80:81], v[76:77] op_sel_hi:[1,0]
    v_pk_mul_f32 v[82:83], v[82:83], v[76:77] op_sel_hi:[1,0]
    v_pk_mul_f32 v[84:85], v[84:85], v[76:77] op_sel_hi:[1,0]
    v_pk_mul_f32 v[86:87], v[86:87], v[76:77] op_sel_hi:[1,0]
    v_pk_mul_f32 v[88:89], v[88:89], v[76:77] op_sel_hi:[1,0]
    v_pk_mul_f32 v[90:91], v[90:91], v[76:77] op_sel_hi:[1,0]
    v_pk_mul_f32 v[92:93], v[92:93], v[76:77] op_sel_hi:[1,0]
    v_pk_mul_f32 v[94:95], v[94:95], v[76:77] op_sel_hi:[1,0]
    v_cvt_pk_bf16_f32 v48, v80, v81
    v_cvt_pk_bf16_f32 v49, v82, v83
    v_cvt_pk_bf16_f32 v50, v84, v85
    v_cvt_pk_bf16_f32 v51, v86, v87
    v_cvt_pk_bf16_f32 v52, v88, v89
    v_cvt_pk_bf16_f32 v53, v90, v91
    v_cvt_pk_bf16_f32 v54, v92, v93
    v_cvt_pk_bf16_f32 v55, v94, v95
    ds_write_b128 v24, v[48:51] offset:0
    ds_write_b128 v25, v[52:55] offset:0
    v_pk_mul_f32 v[96:97], v[96:97], v[78:79] op_sel_hi:[1,0]
    v_pk_mul_f32 v[98:99], v[98:99], v[78:79] op_sel_hi:[1,0]
    v_pk_mul_f32 v[100:101], v[100:101], v[78:79] op_sel_hi:[1,0]
    v_pk_mul_f32 v[102:103], v[102:103], v[78:79] op_sel_hi:[1,0]
    v_pk_mul_f32 v[104:105], v[104:105], v[78:79] op_sel_hi:[1,0]
    v_pk_mul_f32 v[106:107], v[106:107], v[78:79] op_sel_hi:[1,0]
    v_pk_mul_f32 v[108:109], v[108:109], v[78:79] op_sel_hi:[1,0]
    v_pk_mul_f32 v[110:111], v[110:111], v[78:79] op_sel_hi:[1,0]
    v_cvt_pk_bf16_f32 v56, v96, v97
    v_cvt_pk_bf16_f32 v57, v98, v99
    v_cvt_pk_bf16_f32 v58, v100, v101
    v_cvt_pk_bf16_f32 v59, v102, v103
    v_cvt_pk_bf16_f32 v60, v104, v105
    v_cvt_pk_bf16_f32 v61, v106, v107
    v_cvt_pk_bf16_f32 v62, v108, v109
    v_cvt_pk_bf16_f32 v63, v110, v111
    ds_write_b128 v26, v[56:59] offset:0
    ds_write_b128 v27, v[60:63] offset:0
    v_accvgpr_read_b32 v12, a238
    v_accvgpr_read_b32 v14, a239
    v_xor_b32 v13, 32, v12
    v_xor_b32 v15, 32, v14
    v_mov_b32 v76, s54
    v_mov_b32 v77, s54
    v_mov_b32 v78, s54
    v_mov_b32 v79, s54
    s_waitcnt lgkmcnt(0)
    s_barrier
    ds_read_b64_tr_b16 v[80:81], v12 offset:0
    ds_read_b64_tr_b16 v[82:83], v13 offset:256
    ds_read_b64_tr_b16 v[84:85], v14 offset:16384
    ds_read_b64_tr_b16 v[86:87], v15 offset:16640
    ds_read_b64_tr_b16 v[88:89], v12 offset:2048
    ds_read_b64_tr_b16 v[90:91], v13 offset:2304
    ds_read_b64_tr_b16 v[92:93], v14 offset:18432
    ds_read_b64_tr_b16 v[94:95], v15 offset:18688
    ds_read_b64_tr_b16 v[96:97], v12 offset:4096
    ds_read_b64_tr_b16 v[98:99], v13 offset:4352
    ds_read_b64_tr_b16 v[100:101], v14 offset:20480
    ds_read_b64_tr_b16 v[102:103], v15 offset:20736
    ds_read_b64_tr_b16 v[104:105], v12 offset:6144
    ds_read_b64_tr_b16 v[106:107], v13 offset:6400
    ds_read_b64_tr_b16 v[108:109], v14 offset:22528
    ds_read_b64_tr_b16 v[110:111], v15 offset:22784
    v_lshlrev_b32 v20, 3, v0
    v_accvgpr_read_b32 v21, a240
    s_waitcnt lgkmcnt(12)
    v_mfma_f32_16x16x32_bf16 v[32:35], v[80:83], v[84:87], 0
    v_mfma_f32_16x16x32_bf16 v[36:39], v[80:83], v[76:79], 0
    s_waitcnt lgkmcnt(8)
    v_mfma_f32_16x16x32_bf16 v[32:35], v[88:91], v[92:95], v[32:35]
    v_mfma_f32_16x16x32_bf16 v[36:39], v[88:91], v[76:79], v[36:39]
    s_waitcnt lgkmcnt(4)
    v_mfma_f32_16x16x32_bf16 v[32:35], v[96:99], v[100:103], v[32:35]
    v_mfma_f32_16x16x32_bf16 v[36:39], v[96:99], v[76:79], v[36:39]
    s_waitcnt lgkmcnt(0)
    v_mfma_f32_16x16x32_bf16 v[32:35], v[104:107], v[108:111], v[32:35]
    v_mfma_f32_16x16x32_bf16 v[36:39], v[104:107], v[76:79], v[36:39]
    v_add_u32 v16, 131072, v16
    v_add_u32 v17, 131072, v17
    v_add_u32 v18, 131072, v18
    v_add_u32 v19, 131072, v19
    v_accvgpr_read_b32 v12, a236
    v_add_u32 v13, 7168, v12
    v_add_u32 v14, 14336, v12
    v_add_u32 v15, 21504, v12
    v_cvt_pk_bf16_f32 v64, v32, v33
    v_cvt_pk_bf16_f32 v65, v34, v35
    buffer_store_dwordx2 v[64:65], v20, s[40:43], s64 offen sc1
    s_mov_b32 exec_lo, 0x00010001
    s_mov_b32 exec_hi, 0x00010001
    buffer_store_dwordx4 v[36:39], v21, s[40:43], s64 offen offset:2048 sc1
    s_mov_b64 exec, -1
    s_waitcnt vmcnt(6)
    s_barrier
    ds_read_b64_tr_b16 v[80:81], v16 offset:0
    ds_read_b64_tr_b16 v[82:83], v16 offset:256
    ds_read_b64_tr_b16 v[84:85], v16 offset:1024
    ds_read_b64_tr_b16 v[86:87], v16 offset:1280
    ds_read_b64_tr_b16 v[88:89], v16 offset:8192
    ds_read_b64_tr_b16 v[90:91], v16 offset:8448
    ds_read_b64_tr_b16 v[92:93], v16 offset:9216
    ds_read_b64_tr_b16 v[94:95], v16 offset:9472
    ds_read_b64_tr_b16 v[96:97], v16 offset:16384
    ds_read_b64_tr_b16 v[98:99], v16 offset:16640
    ds_read_b64_tr_b16 v[100:101], v16 offset:17408
    ds_read_b64_tr_b16 v[102:103], v16 offset:17664
    ds_read_b64_tr_b16 v[104:105], v16 offset:24576
    ds_read_b64_tr_b16 v[106:107], v16 offset:24832
    ds_read_b64_tr_b16 v[108:109], v16 offset:25600
    ds_read_b64_tr_b16 v[110:111], v16 offset:25856
    ds_read_b64_tr_b16 a[0:1], v17 offset:0
    ds_read_b64_tr_b16 a[2:3], v17 offset:256
    ds_read_b64_tr_b16 a[4:5], v17 offset:1024
    ds_read_b64_tr_b16 a[6:7], v17 offset:1280
    ds_read_b64_tr_b16 a[8:9], v17 offset:8192
    ds_read_b64_tr_b16 a[10:11], v17 offset:8448
    ds_read_b64_tr_b16 a[12:13], v17 offset:9216
    ds_read_b64_tr_b16 a[14:15], v17 offset:9472
    v_mov_b32 v29, 0
    s_waitcnt lgkmcnt(8)
    v_dot2_f32_bf16 v29, v80, s54, v29
    v_dot2_f32_bf16 v118, v81, s54, v118
    v_dot2_f32_bf16 v29, v82, s54, v29
    v_dot2_f32_bf16 v118, v83, s54, v118
    v_dot2_f32_bf16 v29, v84, s54, v29
    v_dot2_f32_bf16 v118, v85, s54, v118
    v_dot2_f32_bf16 v29, v86, s54, v29
    v_dot2_f32_bf16 v118, v87, s54, v118
    v_dot2_f32_bf16 v29, v88, s54, v29
    v_dot2_f32_bf16 v118, v89, s54, v118
    v_dot2_f32_bf16 v29, v90, s54, v29
    v_dot2_f32_bf16 v118, v91, s54, v118
    v_dot2_f32_bf16 v29, v92, s54, v29
    v_dot2_f32_bf16 v118, v93, s54, v118
    v_dot2_f32_bf16 v29, v94, s54, v29
    v_dot2_f32_bf16 v118, v95, s54, v118
    v_dot2_f32_bf16 v29, v96, s54, v29
    v_dot2_f32_bf16 v118, v97, s54, v118
    v_dot2_f32_bf16 v29, v98, s54, v29
    v_dot2_f32_bf16 v118, v99, s54, v118
    v_dot2_f32_bf16 v29, v100, s54, v29
    v_dot2_f32_bf16 v118, v101, s54, v118
    v_dot2_f32_bf16 v29, v102, s54, v29
    v_dot2_f32_bf16 v118, v103, s54, v118
    v_dot2_f32_bf16 v29, v104, s54, v29
    v_dot2_f32_bf16 v118, v105, s54, v118
    v_dot2_f32_bf16 v29, v106, s54, v29
    v_dot2_f32_bf16 v118, v107, s54, v118
    v_dot2_f32_bf16 v29, v108, s54, v29
    v_dot2_f32_bf16 v118, v109, s54, v118
    v_dot2_f32_bf16 v29, v110, s54, v29
    v_dot2_f32_bf16 v118, v111, s54, v118
    v_lshlrev_b32 v28, 2, v0
    s_nop 1
    v_add_f32 v118, v118, v29
    ds_write_b32 v28, v118 offset:28672
    v_mfma_f32_32x32x16_bf16 v[64:79], v[80:83], v[128:131], 0
    ds_read_b64_tr_b16 a[16:17], v17 offset:16384
    ds_read_b64_tr_b16 a[18:19], v17 offset:16640
    s_add_u32 m0, s57, 4096
    v_mfma_f32_32x32x16_bf16 v[64:79], v[84:87], v[144:147], v[64:79]
    ds_read_b64_tr_b16 a[20:21], v17 offset:17408
    ds_read_b64_tr_b16 a[22:23], v17 offset:17664
    buffer_load_dwordx4 v6, s[16:19], s79 offen offset:0 lds
    buffer_load_dwordx4 v7, s[16:19], s79 offen offset:1024 lds
    v_mfma_f32_32x32x16_bf16 v[64:79], v[88:91], v[160:163], v[64:79]
    ds_read_b64_tr_b16 a[24:25], v17 offset:24576
    ds_read_b64_tr_b16 a[26:27], v17 offset:24832
    buffer_load_dwordx4 v8, s[16:19], s79 offen offset:2048 lds
    v_mfma_f32_32x32x16_bf16 v[64:79], v[92:95], v[176:179], v[64:79]
    ds_read_b64_tr_b16 a[28:29], v17 offset:25600
    ds_read_b64_tr_b16 a[30:31], v17 offset:25856
    buffer_load_dwordx4 v9, s[16:19], s79 offen offset:3072 lds
    v_mfma_f32_32x32x16_bf16 v[64:79], v[96:99], v[192:195], v[64:79]
    ds_read_b64_tr_b16 a[32:33], v18 offset:0
    ds_read_b64_tr_b16 a[34:35], v18 offset:256
    s_add_u32 s79, s79, 32768
    s_and_b32 s79, s79, 262143
    v_mfma_f32_32x32x16_bf16 v[64:79], v[100:103], v[208:211], v[64:79]
    ds_read_b64_tr_b16 a[36:37], v18 offset:1024
    ds_read_b64_tr_b16 a[38:39], v18 offset:1280
    s_add_u32 m0, s57, 8192
    v_mfma_f32_32x32x16_bf16 v[64:79], v[104:107], v[224:227], v[64:79]
    ds_read_b64_tr_b16 a[40:41], v18 offset:8192
    ds_read_b64_tr_b16 a[42:43], v18 offset:8448
    buffer_load_dwordx4 v6, s[16:19], s79 offen offset:0 lds
    v_mfma_f32_32x32x16_bf16 v[64:79], v[108:111], v[240:243], v[64:79]
    ds_read_b64_tr_b16 a[44:45], v18 offset:9216
    ds_read_b64_tr_b16 a[46:47], v18 offset:9472
    buffer_load_dwordx4 v7, s[16:19], s79 offen offset:1024 lds
    s_waitcnt lgkmcnt(15)
    v_mfma_f32_32x32x16_bf16 v[64:79], a[0:3], v[132:135], v[64:79]
    ds_read_b64_tr_b16 a[48:49], v18 offset:16384
    ds_read_b64_tr_b16 a[50:51], v18 offset:16640
    buffer_load_dwordx4 v8, s[16:19], s79 offen offset:2048 lds
    v_mfma_f32_32x32x16_bf16 v[64:79], a[4:7], v[148:151], v[64:79]
    ds_read_b64_tr_b16 a[52:53], v18 offset:17408
    ds_read_b64_tr_b16 a[54:55], v18 offset:17664
    buffer_load_dwordx4 v9, s[16:19], s79 offen offset:3072 lds
    v_mfma_f32_32x32x16_bf16 v[64:79], a[8:11], v[164:167], v[64:79]
    ds_read_b64_tr_b16 a[56:57], v18 offset:24576
    ds_read_b64_tr_b16 a[58:59], v18 offset:24832
    s_add_u32 s79, s79, 32768
    s_and_b32 s79, s79, 262143
    v_mfma_f32_32x32x16_bf16 v[64:79], a[12:15], v[180:183], v[64:79]
    ds_read_b64_tr_b16 a[60:61], v18 offset:25600
    ds_read_b64_tr_b16 a[62:63], v18 offset:25856
    v_lshlrev_b32 v28, 11, v1
    s_waitcnt vmcnt(8)
    s_waitcnt lgkmcnt(0)
    s_barrier
    s_cmp_lg_u32 s46, 0
    s_cbranch_scc1 L_nopush_1
    s_add_u32 s88, s66, 0
    s_mov_b64 exec, 0xffff
    buffer_store_dword v121, v28, s[40:43], s88 offen sc1
    s_mov_b64 exec, -1
L_nopush_1:
    s_getreg_b32 s48, hwreg(HW_REG_XCC_ID, 0, 4)
    s_cmp_lg_u32 s46, 0
    s_cbranch_scc1 L_noid_2
    s_add_u32 s88, s85, 163840
    v_add_u32 v31, s48, v121
    s_mov_b64 exec, 1
    buffer_store_dword v31, v3, s[40:43], s88 offen sc1
    s_mov_b64 exec, -1
L_noid_2:
    s_cmp_lg_u32 s46, 2
    s_cbranch_scc1 L_ct_3_e
    s_getpc_b64 s[92:93]
L_ct_3:
    s_lshr_b32 s88, s2, 3
    s_mul_i32 s88, s88, 256
    v_lshl_add_u32 v11, v1, 7, s88
    v_min_u32 v11, L_end-L_ct_3, v11
    s_mov_b64 exec, 0x3
    global_load_dword v11, v11, s[92:93]
    s_mov_b64 exec, -1
L_ct_3_e:
    s_waitcnt lgkmcnt(15)
    v_mfma_f32_32x32x16_bf16 v[64:79], a[16:19], v[196:199], v[64:79]
    ds_read_b64_tr_b16 a[64:65], v19 offset:0
    ds_read_b64_tr_b16 a[66:67], v19 offset:256
    v_mfma_f32_32x32x16_bf16 v[64:79], a[20:23], v[212:215], v[64:79]
    ds_read_b64_tr_b16 a[68:69], v19 offset:1024
    ds_read_b64_tr_b16 a[70:71], v19 offset:1280
    v_mfma_f32_32x32x16_bf16 v[64:79], a[24:27], v[228:231], v[64:79]
    ds_read_b64_tr_b16 a[72:73], v19 offset:8192
    ds_read_b64_tr_b16 a[74:75], v19 offset:8448
    v_mfma_f32_32x32x16_bf16 v[64:79], a[28:31], v[244:247], v[64:79]
    ds_read_b64_tr_b16 a[76:77], v19 offset:9216
    ds_read_b64_tr_b16 a[78:79], v19 offset:9472
    s_waitcnt lgkmcnt(15)
    v_mfma_f32_32x32x16_bf16 v[64:79], a[32:35], v[136:139], v[64:79]
    ds_read_b64_tr_b16 a[80:81], v19 offset:16384
    ds_read_b64_tr_b16 a[82:83], v19 offset:16640
    v_mfma_f32_32x32x16_bf16 v[64:79], a[36:39], v[152:155], v[64:79]
    ds_read_b64_tr_b16 a[84:85], v19 offset:17408
    ds_read_b64_tr_b16 a[86:87], v19 offset:17664
    v_mfma_f32_32x32x16_bf16 v[64:79], a[40:43], v[168:171], v[64:79]
    ds_read_b64_tr_b16 a[88:89], v19 offset:24576
    ds_read_b64_tr_b16 a[90:91], v19 offset:24832
    v_mfma_f32_32x32x16_bf16 v[64:79], a[44:47], v[184:187], v[64:79]
    ds_read_b64_tr_b16 a[92:93], v19 offset:25600
    ds_read_b64_tr_b16 a[94:95], v19 offset:25856
    s_waitcnt lgkmcnt(15)
    v_mfma_f32_32x32x16_bf16 v[64:79], a[48:51], v[200:203], v[64:79]
    v_mfma_f32_32x32x16_bf16 v[64:79], a[52:55], v[216:219], v[64:79]
    ds_read_b32 v24, v3 offset:28672
    ds_read_b32 v25, v3 offset:28928
    v_mfma_f32_32x32x16_bf16 v[64:79], a[56:59], v[232:235], v[64:79]
    ds_read_b32 v26, v3 offset:29184
    ds_read_b32 v27, v3 offset:29440
    v_mfma_f32_32x32x16_bf16 v[64:79], a[60:63], v[248:251], v[64:79]
    s_add_u32 m0, s57, 12288
    s_waitcnt lgkmcnt(12)
    v_mfma_f32_32x32x16_bf16 v[64:79], a[64:67], v[140:143], v[64:79]
    s_waitcnt lgkmcnt(2)
    v_add_f32 v24, v24, v25
    s_waitcnt lgkmcnt(0)
    v_add_f32 v26, v26, v27
    v_mfma_f32_32x32x16_bf16 v[64:79], a[68:71], v[156:159], v[64:79]
    buffer_load_dwordx4 v6, s[16:19], s79 offen offset:0 lds
    v_add_f32 v118, v24, v26
    v_mfma_f32_32x32x16_bf16 v[64:79], a[72:75], v[172:175], v[64:79]
    buffer_load_dwordx4 v7, s[16:19], s79 offen offset:1024 lds
    v_cvt_pk_bf16_f32 v24, v118, v118
    v_mfma_f32_32x32x16_bf16 v[64:79], a[76:79], v[188:191], v[64:79]
    buffer_load_dwordx4 v8, s[16:19], s79 offen offset:2048 lds
    s_waitcnt lgkmcnt(4)
    v_mfma_f32_32x32x16_bf16 v[64:79], a[80:83], v[204:207], v[64:79]
    v_and_b32 v29, 0xffff0000, v24
    v_sub_f32 v30, v118, v29
    v_mfma_f32_32x32x16_bf16 v[64:79], a[84:87], v[220:223], v[64:79]
    buffer_load_dwordx4 v9, s[16:19], s79 offen offset:3072 lds
    v_cvt_pk_bf16_f32 v25, v30, 0
    v_mfma_f32_32x32x16_bf16 v[64:79], a[88:91], v[236:239], v[64:79]
    s_add_u32 s79, s79, 32768
    v_mov_b32 v26, 0
    v_mfma_f32_32x32x16_bf16 v[64:79], a[92:95], v[252:255], v[64:79]
    s_and_b32 s79, s79, 262143
    v_mov_b32 v27, 0
    s_nop 1
    v_mfma_f32_32x32x16_bf16 v[64:79], v[24:27], v[124:127], v[64:79]
    v_accvgpr_read_b32 v114, a234
    v_xor_b32 v115, 512, v114
    v_add_u32 v116, 131072, v114
    v_add_u32 v117, 131072, v115
    v_accvgpr_read_b32 v16, a237
    v_add_u32 v17, -896, v16
    v_add_u32 v18, 26624, v16
    v_add_u32 v19, 25728, v16
    s_add_u32 m0, s91, 32768
    s_nop 0
    buffer_load_dwordx4 v16, s[20:23], s80 offen offset:0 lds
    buffer_load_dwordx4 v17, s[20:23], s80 offen offset:1024 lds
    buffer_load_dwordx4 v18, s[20:23], s80 offen offset:2048 lds
    buffer_load_dwordx4 v19, s[20:23], s80 offen offset:3072 lds
    s_add_u32 s80, s80, 229376
    s_cmp_eq_u32 s80, 1835008
    s_cmov_b32 s80, 0
    s_add_u32 m0, s91, 49152
    s_nop 0
    buffer_load_dwordx4 v16, s[20:23], s80 offen offset:0 lds
    buffer_load_dwordx4 v17, s[20:23], s80 offen offset:1024 lds
    buffer_load_dwordx4 v18, s[20:23], s80 offen offset:2048 lds
    buffer_load_dwordx4 v19, s[20:23], s80 offen offset:3072 lds
    s_add_u32 s80, s80, 229376
    s_cmp_eq_u32 s80, 1835008
    s_cmov_b32 s80, 0
    v_cvt_pk_bf16_f32 v80, v64, v65
    v_cvt_pk_bf16_f32 v81, v66, v67
    v_cvt_pk_bf16_f32 v82, v68, v69
    v_cvt_pk_bf16_f32 v83, v70, v71
    v_cvt_pk_bf16_f32 v84, v72, v73
    v_cvt_pk_bf16_f32 v85, v74, v75
    v_cvt_pk_bf16_f32 v86, v76, v77
    v_cvt_pk_bf16_f32 v87, v78, v79
    v_mfma_f32_32x32x16_bf16 v[32:47], a[224:227], v[80:83], 0
    s_nop 0
    v_mfma_f32_32x32x16_bf16 v[32:47], a[228:231], v[84:87], v[32:47]
    v_accvgpr_read_b32 v20, a244
    v_accvgpr_read_b32 v21, a241
    v_accvgpr_read_b32 v22, a243
    v_accvgpr_read_b32 v23, a242
    v_accvgpr_read_b32 v24, a245
    v_lshlrev_b32 v10, 7, v1
    s_nop 5
    v_max3_f32 v48, v32, v33, v34
    v_min3_f32 v50, v32, v33, v34
    v_max3_f32 v49, v35, v36, v37
    v_min3_f32 v51, v35, v36, v37
    v_max3_f32 v48, v48, v38, v39
    v_min3_f32 v50, v50, v38, v39
    v_max3_f32 v49, v49, v40, v41
    v_min3_f32 v51, v51, v40, v41
    v_max3_f32 v48, v48, v42, v43
    v_min3_f32 v50, v50, v42, v43
    v_max3_f32 v49, v49, v44, v45
    v_min3_f32 v51, v51, v44, v45
    v_max3_f32 v48, v48, v46, v47
    v_min3_f32 v50, v50, v46, v47
    v_max_f32 v48, v48, v49
    v_min_f32 v50, v50, v51
    v_mul_f32 v48, v48, v123
    v_mul_f32 v50, v50, v122
    v_pk_fma_f32 v[80:81], v[32:33], v[122:123], v[48:49] op_sel_hi:[1,0,0]
    v_pk_fma_f32 v[96:97], v[32:33], v[122:123], v[50:51] op_sel:[0,1,0] op_sel_hi:[1,1,0]
    s_cmp_lg_u32 s46, 0
    s_cbranch_scc1 L_nopoll_4
    s_add_u32 s88, s68, 0
    s_mov_b64 exec, 0xffff
L_poll_5:
    buffer_load_dword v31, v3, s[40:43], s88 offen sc1
    s_add_u32 s59, s59, 1
    s_cmp_gt_u32 s59, 400000
    s_cbranch_scc1 L_poll_5_y
    s_waitcnt vmcnt(0)
    v_cmp_ne_u32 vcc, s36, v31
    s_nop 0
    s_cbranch_vccnz L_poll_5
L_poll_5_y:
    s_waitcnt vmcnt(0)
    s_mov_b64 exec, -1
L_nopoll_4:
    s_barrier
    buffer_load_dwordx4 v[192:195], v20, s[40:43], s65 offen sc1
    buffer_load_dwordx4 v[224:227], v21, s[40:43], s65 offen offset:2048 sc1
    s_add_u32 s65, s65, 4608
    buffer_load_dwordx4 v[196:199], v20, s[40:43], s65 offen sc1
    s_add_u32 s65, s65, 4608
    buffer_load_dwordx4 v[200:203], v20, s[40:43], s65 offen sc1
    s_add_u32 s65, s65, 4608
    buffer_load_dwordx4 v[204:207], v20, s[40:43], s65 offen sc1
    s_add_u32 s65, s65, 4608
    buffer_load_dwordx4 v[208:211], v20, s[40:43], s65 offen sc1
    s_add_u32 s65, s65, 4608
    buffer_load_dwordx4 v[212:215], v20, s[40:43], s65 offen sc1
    s_add_u32 s65, s65, 4608
    buffer_load_dwordx4 v[216:219], v20, s[40:43], s65 offen sc1
    s_add_u32 s65, s65, 4608
    buffer_load_dwordx4 v[220:223], v20, s[40:43], s65 offen sc1
    v_pk_fma_f32 v[82:83], v[34:35], v[122:123], v[48:49] op_sel_hi:[1,0,0]
    v_pk_fma_f32 v[98:99], v[34:35], v[122:123], v[50:51] op_sel:[0,1,0] op_sel_hi:[1,1,0]
    v_pk_fma_f32 v[84:85], v[36:37], v[122:123], v[48:49] op_sel_hi:[1,0,0]
    v_pk_fma_f32 v[100:101], v[36:37], v[122:123], v[50:51] op_sel:[0,1,0] op_sel_hi:[1,1,0]
    v_pk_fma_f32 v[86:87], v[38:39], v[122:123], v[48:49] op_sel_hi:[1,0,0]
    v_pk_fma_f32 v[102:103], v[38:39], v[122:123], v[50:51] op_sel:[0,1,0] op_sel_hi:[1,1,0]
    v_pk_fma_f32 v[88:89], v[40:41], v[122:123], v[48:49] op_sel_hi:[1,0,0]
    v_pk_fma_f32 v[104:105], v[40:41], v[122:123], v[50:51] op_sel:[0,1,0] op_sel_hi:[1,1,0]
    v_pk_fma_f32 v[90:91], v[42:43], v[122:123], v[48:49] op_sel_hi:[1,0,0]
    v_pk_fma_f32 v[106:107], v[42:43], v[122:123], v[50:51] op_sel:[0,1,0] op_sel_hi:[1,1,0]
    v_pk_fma_f32 v[92:93], v[44:45], v[122:123], v[48:49] op_sel_hi:[1,0,0]
    v_pk_fma_f32 v[108:109], v[44:45], v[122:123], v[50:51] op_sel:[0,1,0] op_sel_hi:[1,1,0]
    v_pk_fma_f32 v[94:95], v[46:47], v[122:123], v[48:49] op_sel_hi:[1,0,0]
    v_pk_fma_f32 v[110:111], v[46:47], v[122:123], v[50:51] op_sel:[0,1,0] op_sel_hi:[1,1,0]
    v_exp_f32 v80, v80
    v_exp_f32 v81, v81
    v_exp_f32 v82, v82
    v_exp_f32 v83, v83
    v_exp_f32 v84, v84
    v_exp_f32 v85, v85
    v_exp_f32 v86, v86
    v_exp_f32 v87, v87
    v_exp_f32 v88, v88
    v_exp_f32 v89, v89
    v_exp_f32 v90, v90
    v_exp_f32 v91, v91
    v_exp_f32 v92, v92
    v_exp_f32 v93, v93
    v_exp_f32 v94, v94
    v_exp_f32 v95, v95
    v_exp_f32 v96, v96
    v_exp_f32 v97, v97
    v_exp_f32 v98, v98
    v_exp_f32 v99, v99
    v_exp_f32 v100, v100
    v_exp_f32 v101, v101
    v_exp_f32 v102, v102
    v_exp_f32 v103, v103
    v_exp_f32 v104, v104
    v_exp_f32 v105, v105
    v_exp_f32 v106, v106
    v_exp_f32 v107, v107
    v_exp_f32 v108, v108
    v_exp_f32 v109, v109
    v_exp_f32 v110, v110
    v_exp_f32 v111, v111
    s_add_u32 s88, s67, 163840
    s_mov_b64 exec, 0xffff
    buffer_load_dword v113, v3, s[40:43], s88 offen sc1
    s_mov_b64 exec, -1
L_noci_6:
    s_cmp_lg_u32 s46, 1
    s_cbranch_scc1 L_nowf_7
    s_waitcnt vmcnt(22)
    v_lshlrev_b32 v11, 15, v1
    v_lshlrev_b32 v31, 7, v1
    v_add_u32 v31, 97664, v31
    v_cmp_lt_u32 vcc, 5, v1
    s_nop 1
    v_cndmask_b32 v11, v11, v31, vcc
    v_writelane_b32 v11, s37, 8
    s_mov_b64 exec, 0x1de
    buffer_load_dword v11, v11, s[40:43], s67 offen sc1
    s_mov_b64 exec, -1
L_nowf_7:
    v_pk_add_f32 v[52:53], v[80:81], v[82:83]
    v_pk_add_f32 v[54:55], v[96:97], v[98:99]
    v_pk_add_f32 v[52:53], v[52:53], v[84:85]
    v_pk_add_f32 v[54:55], v[54:55], v[100:101]
    v_pk_add_f32 v[52:53], v[52:53], v[86:87]
    v_pk_add_f32 v[54:55], v[54:55], v[102:103]
    v_pk_add_f32 v[52:53], v[52:53], v[88:89]
    v_pk_add_f32 v[54:55], v[54:55], v[104:105]
    v_pk_add_f32 v[52:53], v[52:53], v[90:91]
    v_pk_add_f32 v[54:55], v[54:55], v[106:107]
    v_pk_add_f32 v[52:53], v[52:53], v[92:93]
    v_pk_add_f32 v[54:55], v[54:55], v[108:109]
    v_pk_add_f32 v[52:53], v[52:53], v[94:95]
    v_pk_add_f32 v[54:55], v[54:55], v[110:111]
    v_add_f32 v52, v52, v53
    v_add_f32 v54, v54, v55
    v_rcp_f32 v52, v52
    v_rcp_f32 v54, v54
    v_pk_mul_f32 v[80:81], v[80:81], v[52:53] op_sel_hi:[1,0]
    v_pk_mul_f32 v[82:83], v[82:83], v[52:53] op_sel_hi:[1,0]
    v_pk_mul_f32 v[84:85], v[84:85], v[52:53] op_sel_hi:[1,0]
    v_pk_mul_f32 v[86:87], v[86:87], v[52:53] op_sel_hi:[1,0]
    v_pk_mul_f32 v[88:89], v[88:89], v[52:53] op_sel_hi:[1,0]
    v_pk_mul_f32 v[90:91], v[90:91], v[52:53] op_sel_hi:[1,0]
    v_pk_mul_f32 v[92:93], v[92:93], v[52:53] op_sel_hi:[1,0]
    v_pk_mul_f32 v[94:95], v[94:95], v[52:53] op_sel_hi:[1,0]
    v_cvt_pk_bf16_f32 v64, v80, v81
    v_cvt_pk_bf16_f32 v65, v82, v83
    v_cvt_pk_bf16_f32 v66, v84, v85
    v_cvt_pk_bf16_f32 v67, v86, v87
    v_cvt_pk_bf16_f32 v68, v88, v89
    v_cvt_pk_bf16_f32 v69, v90, v91
    v_cvt_pk_bf16_f32 v70, v92, v93
    v_cvt_pk_bf16_f32 v71, v94, v95
    v_pk_mul_f32 v[96:97], v[96:97], v[54:55] op_sel_hi:[1,0]
    v_pk_mul_f32 v[98:99], v[98:99], v[54:55] op_sel_hi:[1,0]
    v_pk_mul_f32 v[100:101], v[100:101], v[54:55] op_sel_hi:[1,0]
    v_pk_mul_f32 v[102:103], v[102:103], v[54:55] op_sel_hi:[1,0]
    v_pk_mul_f32 v[104:105], v[104:105], v[54:55] op_sel_hi:[1,0]
    v_pk_mul_f32 v[106:107], v[106:107], v[54:55] op_sel_hi:[1,0]
    v_pk_mul_f32 v[108:109], v[108:109], v[54:55] op_sel_hi:[1,0]
    v_pk_mul_f32 v[110:111], v[110:111], v[54:55] op_sel_hi:[1,0]
    v_cvt_pk_bf16_f32 v72, v96, v97
    v_cvt_pk_bf16_f32 v73, v98, v99
    v_cvt_pk_bf16_f32 v74, v100, v101
    v_cvt_pk_bf16_f32 v75, v102, v103
    v_cvt_pk_bf16_f32 v76, v104, v105
    v_cvt_pk_bf16_f32 v77, v106, v107
    v_cvt_pk_bf16_f32 v78, v108, v109
    v_cvt_pk_bf16_f32 v79, v110, v111
    v_permlane32_swap_b32 v64, v68
    v_permlane32_swap_b32 v72, v76
    v_permlane32_swap_b32 v65, v69
    v_permlane32_swap_b32 v73, v77
    v_permlane32_swap_b32 v66, v70
    v_permlane32_swap_b32 v74, v78
    v_permlane32_swap_b32 v67, v71
    v_permlane32_swap_b32 v75, v79
    v_accvgpr_read_b32 v28, a248
    v_add_u32 v29, 15360, v28
    s_add_u32 m0, s86, 135168
    s_nop 0
    buffer_load_dwordx4 v28, s[4:7], s73 offen lds
    buffer_load_dwordx4 v29, s[4:7], s73 offen offset:1024 lds
    s_waitcnt vmcnt(10)
    v_add_f32_dpp v224, v224, v224 row_ror:1 row_mask:0xf bank_mask:0xf
    v_add_f32_dpp v225, v225, v225 row_ror:1 row_mask:0xf bank_mask:0xf
    v_add_f32_dpp v226, v226, v226 row_ror:1 row_mask:0xf bank_mask:0xf
    v_add_f32_dpp v227, v227, v227 row_ror:1 row_mask:0xf bank_mask:0xf
    v_add_f32_dpp v224, v224, v224 row_ror:2 row_mask:0xf bank_mask:0xf
    v_add_f32_dpp v225, v225, v225 row_ror:2 row_mask:0xf bank_mask:0xf
    v_add_f32_dpp v226, v226, v226 row_ror:2 row_mask:0xf bank_mask:0xf
    v_add_f32_dpp v227, v227, v227 row_ror:2 row_mask:0xf bank_mask:0xf
    v_add_f32_dpp v224, v224, v224 row_ror:4 row_mask:0xf bank_mask:0xf
    v_add_f32_dpp v225, v225, v225 row_ror:4 row_mask:0xf bank_mask:0xf
    v_add_f32_dpp v226, v226, v226 row_ror:4 row_mask:0xf bank_mask:0xf
    v_add_f32_dpp v227, v227, v227 row_ror:4 row_mask:0xf bank_mask:0xf
    v_add_f32_dpp v224, v224, v224 row_ror:8 row_mask:0xf bank_mask:0xf
    v_add_f32_dpp v225, v225, v225 row_ror:8 row_mask:0xf bank_mask:0xf
    v_add_f32_dpp v226, v226, v226 row_ror:8 row_mask:0xf bank_mask:0xf
    v_add_f32_dpp v227, v227, v227 row_ror:8 row_mask:0xf bank_mask:0xf
    v_cvt_pk_bf16_f32 v38, v224, v225
    v_cvt_pk_bf16_f32 v39, v226, v227
    ds_write_b64 v23, v[38:39] offset:1280
    s_waitcnt vmcnt(8)
    v_dot2_f32_bf16 v40, v192, s55, 0
    v_dot2_f32_bf16 v41, v192, s56, 0
    v_dot2_f32_bf16 v42, v193, s55, 0
    v_dot2_f32_bf16 v43, v193, s56, 0
    v_dot2_f32_bf16 v44, v194, s55, 0
    v_dot2_f32_bf16 v45, v194, s56, 0
    v_dot2_f32_bf16 v46, v195, s55, 0
    v_dot2_f32_bf16 v47, v195, s56, 0
    v_dot2_f32_bf16 v40, v196, s55, v40
    v_dot2_f32_bf16 v41, v196, s56, v41
    v_dot2_f32_bf16 v42, v197, s55, v42
    v_dot2_f32_bf16 v43, v197, s56, v43
    v_dot2_f32_bf16 v44, v198, s55, v44
    v_dot2_f32_bf16 v45, v198, s56, v45
    v_dot2_f32_bf16 v46, v199, s55, v46
    v_dot2_f32_bf16 v47, v199, s56, v47
    s_waitcnt vmcnt(6)
    v_dot2_f32_bf16 v40, v200, s55, v40
    v_dot2_f32_bf16 v41, v200, s56, v41
    v_dot2_f32_bf16 v42, v201, s55, v42
    v_dot2_f32_bf16 v43, v201, s56, v43
    v_dot2_f32_bf16 v44, v202, s55, v44
    v_dot2_f32_bf16 v45, v202, s56, v45
    v_dot2_f32_bf16 v46, v203, s55, v46
    v_dot2_f32_bf16 v47, v203, s56, v47
    v_dot2_f32_bf16 v40, v204, s55, v40
    v_dot2_f32_bf16 v41, v204, s56, v41
    v_dot2_f32_bf16 v42, v205, s55, v42
    v_dot2_f32_bf16 v43, v205, s56, v43
    v_dot2_f32_bf16 v44, v206, s55, v44
    v_dot2_f32_bf16 v45, v206, s56, v45
    v_dot2_f32_bf16 v46, v207, s55, v46
    v_dot2_f32_bf16 v47, v207, s56, v47
    s_waitcnt vmcnt(4)
    v_dot2_f32_bf16 v40, v208, s55, v40
    v_dot2_f32_bf16 v41, v208, s56, v41
    v_dot2_f32_bf16 v42, v209, s55, v42
    v_dot2_f32_bf16 v43, v209, s56, v43
    v_dot2_f32_bf16 v44, v210, s55, v44
    v_dot2_f32_bf16 v45, v210, s56, v45
    v_dot2_f32_bf16 v46, v211, s55, v46
    v_dot2_f32_bf16 v47, v211, s56, v47
    v_dot2_f32_bf16 v40, v212, s55, v40
    v_dot2_f32_bf16 v41, v212, s56, v41
    v_dot2_f32_bf16 v42, v213, s55, v42
    v_dot2_f32_bf16 v43, v213, s56, v43
    v_dot2_f32_bf16 v44, v214, s55, v44
    v_dot2_f32_bf16 v45, v214, s56, v45
    v_dot2_f32_bf16 v46, v215, s55, v46
    v_dot2_f32_bf16 v47, v215, s56, v47
    s_waitcnt vmcnt(2)
    v_dot2_f32_bf16 v40, v216, s55, v40
    v_dot2_f32_bf16 v41, v216, s56, v41
    v_dot2_f32_bf16 v42, v217, s55, v42
    v_dot2_f32_bf16 v43, v217, s56, v43
    v_dot2_f32_bf16 v44, v218, s55, v44
    v_dot2_f32_bf16 v45, v218, s56, v45
    v_dot2_f32_bf16 v46, v219, s55, v46
    v_dot2_f32_bf16 v47, v219, s56, v47
    v_dot2_f32_bf16 v40, v220, s55, v40
    v_dot2_f32_bf16 v41, v220, s56, v41
    v_dot2_f32_bf16 v42, v221, s55, v42
    v_dot2_f32_bf16 v43, v221, s56, v43
    v_dot2_f32_bf16 v44, v222, s55, v44
    v_dot2_f32_bf16 v45, v222, s56, v45
    v_dot2_f32_bf16 v46, v223, s55, v46
    v_dot2_f32_bf16 v47, v223, s56, v47
    v_permlane32_swap_b32 v40, v44
    v_permlane32_swap_b32 v41, v45
    v_permlane32_swap_b32 v42, v46
    v_permlane32_swap_b32 v43, v47
    v_pk_add_f32 v[32:33], v[40:41], v[44:45]
    v_pk_add_f32 v[34:35], v[42:43], v[46:47]
    v_cvt_pk_bf16_f32 v36, v32, v33
    v_cvt_pk_bf16_f32 v37, v34, v35
    s_add_u32 m0, s91, 0
    s_nop 0
    buffer_load_dwordx4 v16, s[20:23], s80 offen offset:0 lds
    buffer_load_dwordx4 v17, s[20:23], s80 offen offset:1024 lds
    buffer_load_dwordx4 v18, s[20:23], s80 offen offset:2048 lds
    buffer_load_dwordx4 v19, s[20:23], s80 offen offset:3072 lds
    s_add_u32 s80, s80, 229376
    s_cmp_eq_u32 s80, 1835008
    s_cmov_b32 s80, 0
    ds_write_b64 v22, v[36:37]
    s_mov_b64 exec, 0xffff
    v_subrev_u32 v113, s36, v113
    v_cmp_le_u32 vcc, 16, v113
    s_nop 0
    s_cbranch_vccz L_chk_8_x
    s_add_u32 s88, s67, 163840
L_chk_8:
    buffer_load_dword v113, v3, s[40:43], s88 offen sc1
    s_add_u32 s59, s59, 1
    s_cmp_gt_u32 s59, 400000
    s_cbranch_scc1 L_chk_8_y
    s_waitcnt vmcnt(0)
    v_subrev_u32 v113, s36, v113
    v_cmp_le_u32 vcc, 16, v113
    s_nop 0
    s_cbranch_vccnz L_chk_8
L_chk_8_y:
    s_waitcnt vmcnt(0)
L_chk_8_x:
    v_cmp_ne_u32 vcc, s48, v113
    s_nop 0
    s_cmp_eq_u64 vcc, 0
    s_cselect_b32 s60, 1, 0
    s_mov_b64 exec, -1
L_chk_8_z:
    s_waitcnt vmcnt(23)
    s_waitcnt lgkmcnt(0)
    s_barrier
    ds_read_b128 v[80:83], v24 offset:0
    ds_read_b128 v[84:87], v24 offset:32
    ds_read_b128 v[88:91], v24 offset:1360
    ds_read_b128 v[92:95], v24 offset:1392
    s_waitcnt lgkmcnt(3)
    v_mfma_f32_32x32x16_bf16 v[32:47], v[80:83], v[64:67], 0
    s_waitcnt lgkmcnt(2)
    v_mfma_f32_32x32x16_bf16 v[32:47], v[84:87], v[72:75], v[32:47]
    s_waitcnt lgkmcnt(1)
    v_mfma_f32_32x32x16_bf16 v[48:63], v[88:91], v[68:71], 0
    s_waitcnt lgkmcnt(0)
    v_mfma_f32_32x32x16_bf16 v[48:63], v[92:95], v[76:79], v[48:63]
    s_nop 7
    v_add_f32 v40, 0x358637bd, v40
    v_rcp_f32 v40, v40
    s_nop 0
    v_mul_f32 v32, v32, v40
    v_mul_f32 v33, v33, v40
    v_mul_f32 v34, v34, v40
    v_mul_f32 v35, v35, v40
    v_mul_f32 v36, v36, v40
    v_mul_f32 v37, v37, v40
    v_mul_f32 v38, v38, v40
    v_mul_f32 v39, v39, v40
    v_cvt_pk_bf16_f32 v44, v32, v33
    v_cvt_pk_bf16_f32 v45, v34, v35
    v_cvt_pk_bf16_f32 v46, v36, v37
    v_cvt_pk_bf16_f32 v47, v38, v39
    buffer_store_dwordx4 v[44:47], v2, s[40:43], s69 offen offset:0 sc1
    v_add_f32 v56, 0x358637bd, v56
    v_rcp_f32 v56, v56
    s_nop 0
    v_pk_mul_f32 v[48:49], v[48:49], v[56:57] op_sel_hi:[1,0]
    v_pk_mul_f32 v[50:51], v[50:51], v[56:57] op_sel_hi:[1,0]
    v_pk_mul_f32 v[52:53], v[52:53], v[56:57] op_sel_hi:[1,0]
    v_pk_mul_f32 v[54:55], v[54:55], v[56:57] op_sel_hi:[1,0]
    v_cvt_pk_bf16_f32 v60, v48, v49
    v_cvt_pk_bf16_f32 v61, v50, v51
    v_cvt_pk_bf16_f32 v62, v52, v53
    v_cvt_pk_bf16_f32 v63, v54, v55
    buffer_store_dwordx4 v[60:63], v2, s[40:43], s69 offen offset:1024 sc1
    v_accvgpr_read_b32 v122, a233
    v_add_u32 v123, 65536, v122
    v_accvgpr_read_b32 v28, a249
    v_accvgpr_read_b32 v20, a247
    v_xor_b32 v21, 16384, v20
    v_accvgpr_read_b32 v6, a232
    v_xor_b32 v7, 512, v6
    ds_read_b64_tr_b16 a[0:1], v6 offset:0
    s_add_u32 m0, s91, 16384
    ds_read_b64_tr_b16 a[2:3], v6 offset:256
    ds_read_b64_tr_b16 a[4:5], v7 offset:0
    ds_read_b64_tr_b16 a[6:7], v7 offset:256
    ds_read_b64_tr_b16 a[8:9], v6 offset:2048
    ds_read_b64_tr_b16 a[10:11], v6 offset:2304
    ds_read_b64_tr_b16 a[12:13], v7 offset:2048
    ds_read_b64_tr_b16 a[14:15], v7 offset:2304
    ds_read_b64_tr_b16 a[16:17], v6 offset:4096
    buffer_load_dwordx4 v16, s[20:23], s80 offen offset:0 lds
    ds_read_b64_tr_b16 a[18:19], v6 offset:4352
    ds_read_b64_tr_b16 a[20:21], v7 offset:4096
    ds_read_b64_tr_b16 a[22:23], v7 offset:4352
    ds_read_b64_tr_b16 a[24:25], v6 offset:6144
    ds_read_b64_tr_b16 a[26:27], v6 offset:6400
    ds_read_b64_tr_b16 a[28:29], v7 offset:6144
    ds_read_b64_tr_b16 a[30:31], v7 offset:6400
    ds_read_b64_tr_b16 a[32:33], v6 offset:8192
    buffer_load_dwordx4 v17, s[20:23], s80 offen offset:1024 lds
    ds_read_b64_tr_b16 a[34:35], v6 offset:8448
    ds_read_b64_tr_b16 a[36:37], v7 offset:8192
    ds_read_b64_tr_b16 a[38:39], v7 offset:8448
    ds_read_b64_tr_b16 a[40:41], v6 offset:10240
    ds_read_b64_tr_b16 a[42:43], v6 offset:10496
    ds_read_b64_tr_b16 a[44:45], v7 offset:10240
    ds_read_b64_tr_b16 a[46:47], v7 offset:10496
    ds_read_b64_tr_b16 a[48:49], v6 offset:12288
    buffer_load_dwordx4 v18, s[20:23], s80 offen offset:2048 lds
    ds_read_b64_tr_b16 a[50:51], v6 offset:12544
    ds_read_b64_tr_b16 a[52:53], v7 offset:12288
    ds_read_b64_tr_b16 a[54:55], v7 offset:12544
    ds_read_b64_tr_b16 a[56:57], v6 offset:14336
    ds_read_b64_tr_b16 a[58:59], v6 offset:14592
    ds_read_b64_tr_b16 a[60:61], v7 offset:14336
    ds_read_b64_tr_b16 a[62:63], v7 offset:14592
    ds_read_b64_tr_b16 a[64:65], v6 offset:16384
    buffer_load_dwordx4 v19, s[20:23], s80 offen offset:3072 lds
    ds_read_b64_tr_b16 a[66:67], v6 offset:16640
    ds_read_b64_tr_b16 a[68:69], v7 offset:16384
    ds_read_b64_tr_b16 a[70:71], v7 offset:16640
    ds_read_b64_tr_b16 a[72:73], v6 offset:18432
    ds_read_b64_tr_b16 a[74:75], v6 offset:18688
    ds_read_b64_tr_b16 a[76:77], v7 offset:18432
    ds_read_b64_tr_b16 a[78:79], v7 offset:18688
    ds_read_b64_tr_b16 a[80:81], v6 offset:20480
    s_add_u32 s80, s80, 229376
    ds_read_b64_tr_b16 a[82:83], v6 offset:20736
    ds_read_b64_tr_b16 a[84:85], v7 offset:20480
    ds_read_b64_tr_b16 a[86:87], v7 offset:20736
    ds_read_b64_tr_b16 a[88:89], v6 offset:22528
    ds_read_b64_tr_b16 a[90:91], v6 offset:22784
    ds_read_b64_tr_b16 a[92:93], v7 offset:22528
    ds_read_b64_tr_b16 a[94:95], v7 offset:22784
    ds_read_b64_tr_b16 a[96:97], v6 offset:24576
    s_cmp_eq_u32 s80, 1835008
    s_cmov_b32 s80, 0
    ds_read_b64_tr_b16 a[98:99], v6 offset:24832
    ds_read_b64_tr_b16 a[100:101], v7 offset:24576
    ds_read_b64_tr_b16 a[102:103], v7 offset:24832
    ds_read_b64_tr_b16 a[104:105], v6 offset:26624
    ds_read_b64_tr_b16 a[106:107], v6 offset:26880
    ds_read_b64_tr_b16 a[108:109], v7 offset:26624
    ds_read_b64_tr_b16 a[110:111], v7 offset:26880
    ds_read_b64_tr_b16 a[112:113], v6 offset:28672
    ds_read_b64_tr_b16 a[114:115], v6 offset:28928
    ds_read_b64_tr_b16 a[116:117], v7 offset:28672
    ds_read_b64_tr_b16 a[118:119], v7 offset:28928
    ds_read_b64_tr_b16 a[120:121], v6 offset:30720
    ds_read_b64_tr_b16 a[122:123], v6 offset:30976
    ds_read_b64_tr_b16 a[124:125], v7 offset:30720
    ds_read_b64_tr_b16 a[126:127], v7 offset:30976
    s_waitcnt vmcnt(4)
    s_waitcnt lgkmcnt(0)
    s_barrier
    s_cmp_lg_u32 s46, 0
    s_cbranch_scc1 L_noarr_9
    s_add_u32 s88, s85, 32768
    s_mov_b64 exec, 1
    s_cmp_lg_u32 s60, 0
    s_cbranch_scc1 L_noarr_9_l
    buffer_store_dword v121, v3, s[40:43], s88 offen sc1
    s_branch L_noarr_9_e
L_noarr_9_l:
    buffer_store_dword v121, v3, s[40:43], s88 offen
L_noarr_9_e:
    s_mov_b64 exec, -1
L_noarr_9:
    s_cmp_lg_u32 s46, 2
    s_cbranch_scc1 L_ct_10_e
    s_getpc_b64 s[92:93]
L_ct_10:
    s_lshr_b32 s88, s2, 3
    s_mul_i32 s88, s88, 256
    v_lshl_add_u32 v11, v1, 7, s88
    v_min_u32 v11, L_end-L_ct_10, v11
    s_mov_b64 exec, 0x3
    global_load_dword v11, v11, s[92:93]
    s_mov_b64 exec, -1
L_ct_10_e:
    ds_read_b128 v[104:107], v28
    ds_read_b128 v[108:111], v28 offset:16
    ds_read_b64_tr_b16 v[128:129], v122 offset:32768
    s_add_u32 m0, s91, 65536
    ds_read_b64_tr_b16 v[130:131], v122 offset:33024
    ds_read_b64_tr_b16 v[132:133], v122 offset:34816
    ds_read_b64_tr_b16 v[134:135], v122 offset:35072
    buffer_load_dwordx4 v16, s[20:23], s80 offen offset:0 lds
    ds_read_b64_tr_b16 v[136:137], v122 offset:40960
    ds_read_b64_tr_b16 v[138:139], v122 offset:41216
    ds_read_b64_tr_b16 v[140:141], v122 offset:43008
    buffer_load_dwordx4 v17, s[20:23], s80 offen offset:1024 lds
    ds_read_b64_tr_b16 v[142:143], v122 offset:43264
    ds_read_b64_tr_b16 v[144:145], v122 offset:49152
    ds_read_b64_tr_b16 v[146:147], v122 offset:49408
    buffer_load_dwordx4 v18, s[20:23], s80 offen offset:2048 lds
    ds_read_b64_tr_b16 v[148:149], v122 offset:51200
    ds_read_b64_tr_b16 v[150:151], v122 offset:51456
    ds_read_b64_tr_b16 v[152:153], v122 offset:57344
    buffer_load_dwordx4 v19, s[20:23], s80 offen offset:3072 lds
    ds_read_b64_tr_b16 v[154:155], v122 offset:57600
    ds_read_b64_tr_b16 v[156:157], v122 offset:59392
    ds_read_b64_tr_b16 v[158:159], v122 offset:59648
    s_add_u32 s80, s80, 229376
    ds_read_b64_tr_b16 v[160:161], v122 offset:0
    ds_read_b64_tr_b16 v[162:163], v122 offset:256
    ds_read_b64_tr_b16 v[164:165], v122 offset:2048
    s_cmp_eq_u32 s80, 1835008
    s_cmov_b32 s80, 0
    ds_read_b64_tr_b16 v[166:167], v122 offset:2304
    ds_read_b64_tr_b16 v[168:169], v122 offset:8192
    ds_read_b64_tr_b16 v[170:171], v122 offset:8448
    ds_read_b64_tr_b16 v[172:173], v122 offset:10240
    ds_read_b64_tr_b16 v[174:175], v122 offset:10496
    s_waitcnt lgkmcnt(15)
    v_lshlrev_b32 v64, 16, v104
    v_and_b32 v65, 0xffff0000, v104
    v_lshlrev_b32 v66, 16, v105
    v_and_b32 v67, 0xffff0000, v105
    v_lshlrev_b32 v68, 16, v106
    v_and_b32 v69, 0xffff0000, v106
    v_lshlrev_b32 v70, 16, v107
    v_and_b32 v71, 0xffff0000, v107
    v_lshlrev_b32 v72, 16, v108
    v_and_b32 v73, 0xffff0000, v108
    v_lshlrev_b32 v74, 16, v109
    v_and_b32 v75, 0xffff0000, v109
    v_lshlrev_b32 v76, 16, v110
    v_and_b32 v77, 0xffff0000, v110
    v_lshlrev_b32 v78, 16, v111
    v_and_b32 v79, 0xffff0000, v111
    s_cmp_lg_u32 s46, 0
    s_cbranch_scc1 L_nopoll_11
    s_add_u32 s88, s67, 32768
    s_mov_b64 exec, 0xffff
L_poll_12:
    buffer_load_dword v31, v3, s[40:43], s88 offen sc1
    s_add_u32 s59, s59, 1
    s_cmp_gt_u32 s59, 400000
    s_cbranch_scc1 L_poll_12_y
    s_waitcnt vmcnt(0)
    v_cmp_ne_u32 vcc, s36, v31
    s_nop 0
    s_cbranch_vccnz L_poll_12
L_poll_12_y:
    s_waitcnt vmcnt(0)
    s_mov_b64 exec, -1
L_nopoll_11:
    s_waitcnt vmcnt(0)
    s_waitcnt lgkmcnt(0)
    s_barrier
    s_add_u32 s52, s83, s70
    s_add_u32 s83, s83, 4096
    s_and_b32 s83, s83, 16383
    buffer_load_dwordx4 v[192:195], v2, s[40:43], s52 offen offset:0 sc1
    buffer_load_dwordx4 v[196:199], v2, s[40:43], s52 offen offset:1024 sc1
    buffer_load_dwordx4 v[200:203], v2, s[40:43], s52 offen offset:2048 sc1
    buffer_load_dwordx4 v[204:207], v2, s[40:43], s52 offen offset:3072 sc1
    s_add_u32 s52, s83, s70
    s_add_u32 s83, s83, 4096
    s_and_b32 s83, s83, 16383
    buffer_load_dwordx4 v[208:211], v2, s[40:43], s52 offen offset:0 sc1
    buffer_load_dwordx4 v[212:215], v2, s[40:43], s52 offen offset:1024 sc1
    buffer_load_dwordx4 v[216:219], v2, s[40:43], s52 offen offset:2048 sc1
    buffer_load_dwordx4 v[220:223], v2, s[40:43], s52 offen offset:3072 sc1
    s_add_u32 s52, s83, s70
    s_add_u32 s83, s83, 4096
    s_and_b32 s83, s83, 16383
    buffer_load_dwordx4 v[224:227], v2, s[40:43], s52 offen offset:0 sc1
    buffer_load_dwordx4 v[228:231], v2, s[40:43], s52 offen offset:1024 sc1
    ds_read_b64_tr_b16 v[176:177], v122 offset:16384
    ds_read_b64_tr_b16 v[178:179], v122 offset:16640
    ds_read_b64_tr_b16 v[180:181], v122 offset:18432
    ds_read_b64_tr_b16 v[182:183], v122 offset:18688
    ds_read_b64_tr_b16 v[184:185], v122 offset:24576
    ds_read_b64_tr_b16 v[186:187], v122 offset:24832
    ds_read_b64_tr_b16 v[188:189], v122 offset:26624
    ds_read_b64_tr_b16 v[190:191], v122 offset:26880
    s_waitcnt vmcnt(9)
    v_mfma_f32_32x32x16_bf16 v[32:47], a[0:3], v[192:195], v[64:79]
    buffer_load_dwordx4 v[232:235], v2, s[40:43], s52 offen offset:2048 sc1
    v_mfma_f32_32x32x16_bf16 v[48:63], a[4:7], v[192:195], 0
    s_waitcnt vmcnt(9)
    v_mfma_f32_32x32x16_bf16 v[32:47], a[8:11], v[196:199], v[32:47]
    buffer_load_dwordx4 v[236:239], v2, s[40:43], s52 offen offset:3072 sc1
    v_mfma_f32_32x32x16_bf16 v[48:63], a[12:15], v[196:199], v[48:63]
    s_waitcnt vmcnt(9)
    v_mfma_f32_32x32x16_bf16 v[32:47], a[16:19], v[200:203], v[32:47]
    s_add_u32 s52, s83, s70
    s_add_u32 s83, s83, 4096
    s_and_b32 s83, s83, 16383
    buffer_load_dwordx4 v[240:243], v2, s[40:43], s52 offen offset:0 sc1
    v_mfma_f32_32x32x16_bf16 v[48:63], a[20:23], v[200:203], v[48:63]
    s_waitcnt vmcnt(9)
    v_mfma_f32_32x32x16_bf16 v[32:47], a[24:27], v[204:207], v[32:47]
    buffer_load_dwordx4 v[244:247], v2, s[40:43], s52 offen offset:1024 sc1
    v_mfma_f32_32x32x16_bf16 v[48:63], a[28:31], v[204:207], v[48:63]
    s_waitcnt vmcnt(9)
    v_mfma_f32_32x32x16_bf16 v[32:47], a[32:35], v[208:211], v[32:47]
    buffer_load_dwordx4 v[248:251], v2, s[40:43], s52 offen offset:2048 sc1
    v_mfma_f32_32x32x16_bf16 v[48:63], a[36:39], v[208:211], v[48:63]
    s_waitcnt vmcnt(9)
    v_mfma_f32_32x32x16_bf16 v[32:47], a[40:43], v[212:215], v[32:47]
    buffer_load_dwordx4 v[252:255], v2, s[40:43], s52 offen offset:3072 sc1
    v_mfma_f32_32x32x16_bf16 v[48:63], a[44:47], v[212:215], v[48:63]
    s_waitcnt vmcnt(9)
    v_mfma_f32_32x32x16_bf16 v[32:47], a[48:51], v[216:219], v[32:47]
    v_mfma_f32_32x32x16_bf16 v[48:63], a[52:55], v[216:219], v[48:63]
    s_waitcnt vmcnt(8)
    v_mfma_f32_32x32x16_bf16 v[32:47], a[56:59], v[220:223], v[32:47]
    s_add_u32 m0, s91, 81920
    s_nop 0
    buffer_load_dwordx4 v16, s[20:23], s80 offen offset:0 lds
    v_mfma_f32_32x32x16_bf16 v[48:63], a[60:63], v[220:223], v[48:63]
    buffer_load_dwordx4 v17, s[20:23], s80 offen offset:1024 lds
    s_waitcnt vmcnt(9)
    v_mfma_f32_32x32x16_bf16 v[32:47], a[64:67], v[224:227], v[32:47]
    buffer_load_dwordx4 v18, s[20:23], s80 offen offset:2048 lds
    buffer_load_dwordx4 v19, s[20:23], s80 offen offset:3072 lds
    v_mfma_f32_32x32x16_bf16 v[48:63], a[68:71], v[224:227], v[48:63]
    s_add_u32 s80, s80, 229376
    s_waitcnt vmcnt(10)
    v_mfma_f32_32x32x16_bf16 v[32:47], a[72:75], v[228:231], v[32:47]
    s_cmp_eq_u32 s80, 1835008
    s_cmov_b32 s80, 0
    v_mfma_f32_32x32x16_bf16 v[48:63], a[76:79], v[228:231], v[48:63]
    s_add_u32 m0, s91, 98304
    s_nop 0
    buffer_load_dwordx4 v16, s[20:23], s80 offen offset:0 lds
    s_waitcnt vmcnt(10)
    v_mfma_f32_32x32x16_bf16 v[32:47], a[80:83], v[232:235], v[32:47]
    buffer_load_dwordx4 v17, s[20:23], s80 offen offset:1024 lds
    v_mfma_f32_32x32x16_bf16 v[48:63], a[84:87], v[232:235], v[48:63]
    buffer_load_dwordx4 v18, s[20:23], s80 offen offset:2048 lds
    buffer_load_dwordx4 v19, s[20:23], s80 offen offset:3072 lds
    s_waitcnt vmcnt(12)
    v_mfma_f32_32x32x16_bf16 v[48:63], a[92:95], v[236:239], v[48:63]
    s_add_u32 s80, s80, 229376
    s_waitcnt vmcnt(11)
    v_mfma_f32_32x32x16_bf16 v[48:63], a[100:103], v[240:243], v[48:63]
    s_cmp_eq_u32 s80, 1835008
    s_cmov_b32 s80, 0
    s_waitcnt vmcnt(10)
    v_mfma_f32_32x32x16_bf16 v[48:63], a[108:111], v[244:247], v[48:63]
    s_add_u32 m0, s91, 114688
    s_nop 0
    buffer_load_dwordx4 v16, s[20:23], s80 offen offset:0 lds
    s_waitcnt vmcnt(10)
    v_mfma_f32_32x32x16_bf16 v[48:63], a[116:119], v[248:251], v[48:63]
    buffer_load_dwordx4 v17, s[20:23], s80 offen offset:1024 lds
    s_waitcnt vmcnt(10)
    v_mfma_f32_32x32x16_bf16 v[48:63], a[124:127], v[252:255], v[48:63]
    buffer_load_dwordx4 v18, s[20:23], s80 offen offset:2048 lds
    buffer_load_dwordx4 v19, s[20:23], s80 offen offset:3072 lds
    v_mfma_f32_32x32x16_bf16 v[32:47], a[88:91], v[236:239], v[32:47]
    s_add_u32 s80, s80, 229376
    v_mfma_f32_32x32x16_bf16 v[32:47], a[96:99], v[240:243], v[32:47]
    s_cmp_eq_u32 s80, 1835008
    s_cmov_b32 s80, 0
    v_mfma_f32_32x32x16_bf16 v[32:47], a[104:107], v[244:247], v[32:47]
    v_mfma_f32_32x32x16_bf16 v[32:47], a[112:115], v[248:251], v[32:47]
    s_nop 2
    ds_write_b128 v20, v[48:51] offset:0
    ds_write_b128 v20, v[52:55] offset:1024
    v_mfma_f32_32x32x16_bf16 v[32:47], a[120:123], v[252:255], v[32:47]
    ds_write_b128 v20, v[56:59] offset:2048
    ds_write_b128 v20, v[60:63] offset:3072
    s_waitcnt lgkmcnt(0)
    s_barrier
    ds_read_b128 v[48:51], v21 offset:0
    ds_read_b128 v[52:55], v21 offset:1024
    ds_read_b128 v[56:59], v21 offset:2048
    ds_read_b128 v[60:63], v21 offset:3072
    s_waitcnt lgkmcnt(3)
    s_nop 2
    v_pk_add_f32 v[32:33], v[32:33], v[48:49]
    v_pk_add_f32 v[34:35], v[34:35], v[50:51]
    s_waitcnt lgkmcnt(2)
    v_pk_add_f32 v[36:37], v[36:37], v[52:53]
    v_pk_add_f32 v[38:39], v[38:39], v[54:55]
    v_cvt_pk_bf16_f32 v20, v32, v33
    v_cvt_pk_bf16_f32 v21, v34, v35
    v_cvt_pk_bf16_f32 v22, v36, v37
    v_cvt_pk_bf16_f32 v23, v38, v39
    buffer_store_dwordx4 v[20:23], v2, s[40:43], s71 offen offset:0 sc1
    s_waitcnt lgkmcnt(1)
    v_pk_add_f32 v[40:41], v[40:41], v[56:57]
    v_pk_add_f32 v[42:43], v[42:43], v[58:59]
    s_waitcnt lgkmcnt(0)
    v_pk_add_f32 v[44:45], v[44:45], v[60:61]
    v_pk_add_f32 v[46:47], v[46:47], v[62:63]
    v_cvt_pk_bf16_f32 v24, v40, v41
    v_cvt_pk_bf16_f32 v25, v42, v43
    v_cvt_pk_bf16_f32 v26, v44, v45
    v_cvt_pk_bf16_f32 v27, v46, v47
    buffer_store_dwordx4 v[24:27], v2, s[40:43], s71 offen offset:1024 sc1
    v_dot2_f32_bf16 v28, v20, s54, 0
    v_dot2_f32_bf16 v29, v20, v20, 0
    v_dot2_f32_bf16 v28, v21, s54, v28
    v_dot2_f32_bf16 v29, v21, v21, v29
    v_dot2_f32_bf16 v28, v22, s54, v28
    v_dot2_f32_bf16 v29, v22, v22, v29
    v_dot2_f32_bf16 v28, v23, s54, v28
    v_dot2_f32_bf16 v29, v23, v23, v29
    v_dot2_f32_bf16 v28, v24, s54, v28
    v_dot2_f32_bf16 v29, v24, v24, v29
    v_dot2_f32_bf16 v28, v25, s54, v28
    v_dot2_f32_bf16 v29, v25, v25, v29
    v_dot2_f32_bf16 v28, v26, s54, v28
    v_dot2_f32_bf16 v29, v26, v26, v29
    v_dot2_f32_bf16 v28, v27, s54, v28
    v_dot2_f32_bf16 v29, v27, v27, v29
    s_nop 2
    v_permlane32_swap_b32 v28, v29
    v_add_f32 v120, v28, v29
    buffer_store_dword v120, v3, s[40:43], s72 offen sc1
    v_accvgpr_read_b32 v30, a246
    buffer_load_ushort v124, v30, s[24:27], 0 offen
    s_waitcnt lgkmcnt(0)
    v_dot2_f32_bf16 v118, v128, s54, 0
    v_dot2_f32_bf16 v119, v129, s54, 0
    v_dot2_f32_bf16 v118, v130, s54, v118
    v_dot2_f32_bf16 v119, v131, s54, v119
    v_dot2_f32_bf16 v118, v132, s54, v118
    v_dot2_f32_bf16 v119, v133, s54, v119
    v_dot2_f32_bf16 v118, v134, s54, v118
    v_dot2_f32_bf16 v119, v135, s54, v119
    v_dot2_f32_bf16 v118, v136, s54, v118
    v_dot2_f32_bf16 v119, v137, s54, v119
    v_dot2_f32_bf16 v118, v138, s54, v118
    v_dot2_f32_bf16 v119, v139, s54, v119
    v_dot2_f32_bf16 v118, v140, s54, v118
    v_dot2_f32_bf16 v119, v141, s54, v119
    v_dot2_f32_bf16 v118, v142, s54, v118
    v_dot2_f32_bf16 v119, v143, s54, v119
    v_dot2_f32_bf16 v118, v144, s54, v118
    v_dot2_f32_bf16 v119, v145, s54, v119
    v_dot2_f32_bf16 v118, v146, s54, v118
    v_dot2_f32_bf16 v119, v147, s54, v119
    v_dot2_f32_bf16 v118, v148, s54, v118
    v_dot2_f32_bf16 v119, v149, s54, v119
    v_dot2_f32_bf16 v118, v150, s54, v118
    v_dot2_f32_bf16 v119, v151, s54, v119
    v_dot2_f32_bf16 v118, v152, s54, v118
    v_dot2_f32_bf16 v119, v153, s54, v119
    v_dot2_f32_bf16 v118, v154, s54, v118
    v_dot2_f32_bf16 v119, v155, s54, v119
    v_dot2_f32_bf16 v118, v156, s54, v118
    v_dot2_f32_bf16 v119, v157, s54, v119
    v_dot2_f32_bf16 v118, v158, s54, v118
    v_dot2_f32_bf16 v119, v159, s54, v119
    v_dot2_f32_bf16 v118, v160, s54, v118
    v_dot2_f32_bf16 v119, v161, s54, v119
    v_dot2_f32_bf16 v118, v162, s54, v118
    v_dot2_f32_bf16 v119, v163, s54, v119
    v_dot2_f32_bf16 v118, v164, s54, v118
    v_dot2_f32_bf16 v119, v165, s54, v119
    v_dot2_f32_bf16 v118, v166, s54, v118
    v_dot2_f32_bf16 v119, v167, s54, v119
    v_dot2_f32_bf16 v118, v168, s54, v118
    v_dot2_f32_bf16 v119, v169, s54, v119
    v_dot2_f32_bf16 v118, v170, s54, v118
    v_dot2_f32_bf16 v119, v171, s54, v119
    v_dot2_f32_bf16 v118, v172, s54, v118
    v_dot2_f32_bf16 v119, v173, s54, v119
    v_dot2_f32_bf16 v118, v174, s54, v118
    v_dot2_f32_bf16 v119, v175, s54, v119
    v_dot2_f32_bf16 v118, v176, s54, v118
    v_dot2_f32_bf16 v119, v177, s54, v119
    v_dot2_f32_bf16 v118, v178, s54, v118
    v_dot2_f32_bf16 v119, v179, s54, v119
    v_dot2_f32_bf16 v118, v180, s54, v118
    v_dot2_f32_bf16 v119, v181, s54, v119
    v_dot2_f32_bf16 v118, v182, s54, v118
    v_dot2_f32_bf16 v119, v183, s54, v119
    v_dot2_f32_bf16 v118, v184, s54, v118
    v_dot2_f32_bf16 v119, v185, s54, v119
    v_dot2_f32_bf16 v118, v186, s54, v118
    v_dot2_f32_bf16 v119, v187, s54, v119
    v_dot2_f32_bf16 v118, v188, s54, v118
    v_dot2_f32_bf16 v119, v189, s54, v119
    v_dot2_f32_bf16 v118, v190, s54, v118
    v_dot2_f32_bf16 v119, v191, s54, v119
    v_add_u32 v126, 65536, v114
    v_add_u32 v127, 65536, v115
    v_add_u32 v6, s78, v2
    v_add_u32 v7, 114688, v6
    s_mul_i32 s52, s61, 114688
    s_sub_u32 s53, 344064, s52
    s_add_u32 s52, s52, 229376
    v_add_u32 v8, s53, v6
    v_add_u32 v9, s52, v6
    s_or_b32 s52, s61, s90
    s_cmp_eq_u32 s52, 0
    s_cselect_b32 s79, 0x3fb8aa3b, 0
    s_cmp_gt_u32 s61, s90
    s_cselect_b32 s80, 0x3fb8aa3b, 0
    s_cmp_eq_u32 s90, 1
    s_cselect_b32 s83, 0x3fb8aa3b, 0
    s_lshl_b32 s52, s90, 16
    s_lshl_b32 s88, s89, 6
    s_add_u32 s52, s52, s88
    s_sub_u32 s73, s73, s52
    s_cmp_lg_u32 s60, 0
    s_cselect_b32 s52, 0, 0xc00000
    s_mov_b32 s64, s52
    s_lshl_b32 s88, s44, 17
    s_add_u32 s64, s64, s88
    s_lshl_b32 s88, s45, 13
    s_add_u32 s64, s64, s88
    s_lshl_b32 s88, s46, 11
    s_add_u32 s64, s64, s88
    s_add_u32 s64, s64, 2097152
    s_xor_b32 s65, s64, 8192
    s_mov_b32 s69, s67
    s_lshl_b32 s88, s45, 4
    s_add_u32 s69, s69, s88
    s_lshl_b32 s88, s46, 2
    s_add_u32 s69, s69, s88
    s_add_u32 s69, s69, 131072
    s_xor_b32 s66, s69, 16
    s_waitcnt vmcnt(1)
    s_barrier
    s_cmp_lg_u32 s46, 0
    s_cbranch_scc1 L_noarr_13
    s_add_u32 s88, s85, 65536
    s_mov_b64 exec, 1
    s_cmp_lg_u32 s60, 0
    s_cbranch_scc1 L_noarr_13_l
    buffer_store_dword v121, v3, s[40:43], s88 offen sc1
    s_branch L_noarr_13_e
L_noarr_13_l:
    buffer_store_dword v121, v3, s[40:43], s88 offen
L_noarr_13_e:
    s_mov_b64 exec, -1
L_noarr_13:
    s_cmp_lg_u32 s46, 2
    s_cbranch_scc1 L_ct_14_e
    s_getpc_b64 s[92:93]
L_ct_14:
    s_lshr_b32 s88, s2, 3
    s_mul_i32 s88, s88, 512
    v_lshl_add_u32 v11, v1, 7, s88
    v_min_u32 v11, L_end-L_ct_14, v11
    s_mov_b64 exec, 0xf
    global_load_dword v11, v11, s[92:93]
    s_mov_b64 exec, -1
L_ct_14_e:
    s_or_b32 s52, s85, s46
    s_cmp_lg_u32 s52, 60
    s_cbranch_scc1 L_noep
    s_mov_b32 s52, 0x38000
    s_mov_b64 exec, 1
    buffer_store_dword v121, v3, s[40:43], s52 offen sc1
    s_mov_b64 exec, -1
L_noep:
    s_add_u32 m0, s86, 131072
    s_nop 0
    buffer_load_dwordx4 v12, s[28:31], s81 offen offset:0 lds
    buffer_load_dwordx4 v13, s[28:31], s81 offen offset:1024 lds
    buffer_load_dwordx4 v14, s[28:31], s81 offen offset:2048 lds
    buffer_load_dwordx4 v15, s[28:31], s81 offen offset:3072 lds
    s_add_u32 s81, s81, 32768
    s_cmp_eq_u32 s81, 229376
    s_cmov_b32 s81, 0
    s_add_u32 m0, s86, 135168
    s_nop 0
    buffer_load_dwordx4 v12, s[28:31], s81 offen offset:0 lds
    buffer_load_dwordx4 v13, s[28:31], s81 offen offset:1024 lds
    buffer_load_dwordx4 v14, s[28:31], s81 offen offset:2048 lds
    buffer_load_dwordx4 v15, s[28:31], s81 offen offset:3072 lds
    s_add_u32 s81, s81, 32768
    s_cmp_eq_u32 s81, 229376
    s_cmov_b32 s81, 0
    v_mov_b32 v18, v2
    v_add_u32 v19, 65536, v2
    s_lshl_b32 s52, s46, 10
    v_add_u32 v16, s52, v19
    v_mov_b32 v107, 0
    s_cmp_ge_u32 s45, 14
    s_cbranch_scc1 L_idle
    ds_read_b64_tr_b16 v[192:193], v123 offset:0
    ds_read_b64_tr_b16 v[194:195], v123 offset:256
    ds_read_b64_tr_b16 v[196:197], v123 offset:2048
    ds_read_b64_tr_b16 v[198:199], v123 offset:2304
    ds_read_b64_tr_b16 v[200:201], v123 offset:8192
    ds_read_b64_tr_b16 v[202:203], v123 offset:8448
    ds_read_b64_tr_b16 v[204:205], v123 offset:10240
    ds_read_b64_tr_b16 v[206:207], v123 offset:10496
    ds_read_b64_tr_b16 v[208:209], v123 offset:16384
    ds_read_b64_tr_b16 v[210:211], v123 offset:16640
    ds_read_b64_tr_b16 v[212:213], v123 offset:18432
    ds_read_b64_tr_b16 v[214:215], v123 offset:18688
    ds_read_b64_tr_b16 v[216:217], v123 offset:24576
    ds_read_b64_tr_b16 v[218:219], v123 offset:24832
    ds_read_b64_tr_b16 v[220:221], v123 offset:26624
    ds_read_b64_tr_b16 v[222:223], v123 offset:26880
    ds_read_b64_tr_b16 v[224:225], v123 offset:32768
    ds_read_b64_tr_b16 v[226:227], v123 offset:33024
    ds_read_b64_tr_b16 v[228:229], v123 offset:34816
    ds_read_b64_tr_b16 v[230:231], v123 offset:35072
    ds_read_b64_tr_b16 v[232:233], v123 offset:40960
    ds_read_b64_tr_b16 v[234:235], v123 offset:41216
    ds_read_b64_tr_b16 v[236:237], v123 offset:43008
    ds_read_b64_tr_b16 v[238:239], v123 offset:43264
    s_waitcnt lgkmcnt(15)
    v_dot2_f32_bf16 v118, v192, s54, v118
    v_dot2_f32_bf16 v119, v193, s54, v119
    v_dot2_f32_bf16 v118, v194, s54, v118
    v_dot2_f32_bf16 v119, v195, s54, v119
    v_dot2_f32_bf16 v118, v196, s54, v118
    v_dot2_f32_bf16 v119, v197, s54, v119
    v_dot2_f32_bf16 v118, v198, s54, v118
    v_dot2_f32_bf16 v119, v199, s54, v119
    v_dot2_f32_bf16 v118, v200, s54, v118
    v_dot2_f32_bf16 v119, v201, s54, v119
    v_dot2_f32_bf16 v118, v202, s54, v118
    v_dot2_f32_bf16 v119, v203, s54, v119
    v_dot2_f32_bf16 v118, v204, s54, v118
    v_dot2_f32_bf16 v119, v205, s54, v119
    v_dot2_f32_bf16 v118, v206, s54, v118
    v_dot2_f32_bf16 v119, v207, s54, v119
    v_dot2_f32_bf16 v118, v208, s54, v118
    v_dot2_f32_bf16 v119, v209, s54, v119
    s_waitcnt lgkmcnt(14)
    v_dot2_f32_bf16 v118, v210, s54, v118
    v_dot2_f32_bf16 v119, v211, s54, v119
    s_waitcnt lgkmcnt(13)
    v_dot2_f32_bf16 v118, v212, s54, v118
    v_dot2_f32_bf16 v119, v213, s54, v119
    s_waitcnt lgkmcnt(12)
    v_dot2_f32_bf16 v118, v214, s54, v118
    v_dot2_f32_bf16 v119, v215, s54, v119
    s_waitcnt lgkmcnt(11)
    v_dot2_f32_bf16 v118, v216, s54, v118
    v_dot2_f32_bf16 v119, v217, s54, v119
    s_waitcnt lgkmcnt(10)
    v_dot2_f32_bf16 v118, v218, s54, v118
    v_dot2_f32_bf16 v119, v219, s54, v119
    s_waitcnt lgkmcnt(9)
    v_dot2_f32_bf16 v118, v220, s54, v118
    v_dot2_f32_bf16 v119, v221, s54, v119
    s_waitcnt lgkmcnt(8)
    v_dot2_f32_bf16 v118, v222, s54, v118
    v_dot2_f32_bf16 v119, v223, s54, v119
    s_waitcnt lgkmcnt(7)
    v_dot2_f32_bf16 v118, v224, s54, v118
    v_dot2_f32_bf16 v119, v225, s54, v119
    s_waitcnt lgkmcnt(6)
    v_dot2_f32_bf16 v118, v226, s54, v118
    v_dot2_f32_bf16 v119, v227, s54, v119
    s_waitcnt lgkmcnt(5)
    v_dot2_f32_bf16 v118, v228, s54, v118
    v_dot2_f32_bf16 v119, v229, s54, v119
    s_waitcnt lgkmcnt(4)
    v_dot2_f32_bf16 v118, v230, s54, v118
    v_dot2_f32_bf16 v119, v231, s54, v119
    s_waitcnt lgkmcnt(3)
    v_dot2_f32_bf16 v118, v232, s54, v118
    v_dot2_f32_bf16 v119, v233, s54, v119
    s_waitcnt lgkmcnt(2)
    v_dot2_f32_bf16 v118, v234, s54, v118
    v_dot2_f32_bf16 v119, v235, s54, v119
    s_waitcnt lgkmcnt(1)
    v_dot2_f32_bf16 v118, v236, s54, v118
    v_dot2_f32_bf16 v119, v237, s54, v119
    s_waitcnt lgkmcnt(0)
    v_dot2_f32_bf16 v118, v238, s54, v118
    v_dot2_f32_bf16 v119, v239, s54, v119
    s_mul_i32 s52, s45, 10240
    s_mul_i32 s88, s46, 2560
    s_add_u32 s52, s52, s88
    s_lshl_b32 s53, s44, 17
    s_add_u32 s53, s53, 4194304
    v_lshlrev_b32 v29, 7, v1
    v_add_u32 v29, s52, v29
    v_min_u32 v29, 130944, v29
    s_cmp_lg_u32 s46, 0
    s_cbranch_scc1 L_nopoll_15
    s_add_u32 s88, s67, 65536
    s_mov_b64 exec, 0xffff
L_poll_16:
    buffer_load_dword v31, v3, s[40:43], s88 offen sc1
    s_add_u32 s59, s59, 1
    s_cmp_gt_u32 s59, 400000
    s_cbranch_scc1 L_poll_16_y
    s_waitcnt vmcnt(0)
    v_cmp_ne_u32 vcc, s36, v31
    s_nop 0
    s_cbranch_vccnz L_poll_16
L_poll_16_y:
    s_waitcnt vmcnt(0)
    s_mov_b64 exec, -1
L_nopoll_15:
    s_waitcnt vmcnt(12)
    s_waitcnt lgkmcnt(0)
    s_barrier
    s_add_u32 m0, s91, 0
    s_nop 0
    buffer_load_dwordx4 v2, s[40:43], s74 offen offset:0 sc1 lds
    buffer_load_dwordx4 v2, s[40:43], s74 offen offset:1024 sc1 lds
    buffer_load_dwordx4 v2, s[40:43], s74 offen offset:2048 sc1 lds
    buffer_load_dwordx4 v2, s[40:43], s74 offen offset:3072 sc1 lds
    s_add_u32 s74, s74, 32768
    s_add_u32 m0, s91, 16384
    s_nop 0
    buffer_load_dwordx4 v2, s[40:43], s75 offen offset:0 sc1 lds
    buffer_load_dwordx4 v2, s[40:43], s75 offen offset:1024 sc1 lds
    buffer_load_dwordx4 v2, s[40:43], s75 offen offset:2048 sc1 lds
    buffer_load_dwordx4 v2, s[40:43], s75 offen offset:3072 sc1 lds
    s_add_u32 s75, s75, 32768
    s_add_u32 s52, s91, 106496
    v_add_u32 v17, s52, v3
    ds_read_b64_tr_b16 v[240:241], v123 offset:49152
    ds_read_b64_tr_b16 v[242:243], v123 offset:49408
    ds_read_b64_tr_b16 v[244:245], v123 offset:51200
    ds_read_b64_tr_b16 v[246:247], v123 offset:51456
    ds_read_b64_tr_b16 v[248:249], v123 offset:57344
    ds_read_b64_tr_b16 v[250:251], v123 offset:57600
    ds_read_b64_tr_b16 v[252:253], v123 offset:59392
    ds_read_b64_tr_b16 v[254:255], v123 offset:59648
    s_waitcnt lgkmcnt(7)
    v_dot2_f32_bf16 v118, v240, s54, v118
    v_dot2_f32_bf16 v119, v241, s54, v119
    s_waitcnt lgkmcnt(6)
    v_dot2_f32_bf16 v118, v242, s54, v118
    v_dot2_f32_bf16 v119, v243, s54, v119
    s_waitcnt lgkmcnt(5)
    v_dot2_f32_bf16 v118, v244, s54, v118
    v_dot2_f32_bf16 v119, v245, s54, v119
    s_waitcnt lgkmcnt(4)
    v_dot2_f32_bf16 v118, v246, s54, v118
    v_dot2_f32_bf16 v119, v247, s54, v119
    s_waitcnt lgkmcnt(0)
    v_dot2_f32_bf16 v118, v248, s54, v118
    v_dot2_f32_bf16 v119, v249, s54, v119
    v_dot2_f32_bf16 v118, v250, s54, v118
    v_dot2_f32_bf16 v119, v251, s54, v119
    v_dot2_f32_bf16 v118, v252, s54, v118
    v_dot2_f32_bf16 v119, v253, s54, v119
    v_dot2_f32_bf16 v118, v254, s54, v118
    v_dot2_f32_bf16 v119, v255, s54, v119
    s_waitcnt lgkmcnt(0)
    s_waitcnt vmcnt(4)
    s_barrier
    ds_read_b128 a[0:3], v18 offset:0
    ds_read_b128 a[4:7], v18 offset:1024
    ds_read_b128 a[8:11], v18 offset:2048
    ds_read_b128 a[12:15], v18 offset:3072
    ds_read_b128 a[16:19], v18 offset:4096
    ds_read_b128 a[20:23], v18 offset:5120
    ds_read_b128 a[24:27], v18 offset:6144
    ds_read_b128 a[28:31], v18 offset:7168
    s_waitcnt lgkmcnt(4)
    v_mfma_f32_32x32x16_bf16 v[32:47], v[128:131], a[0:3], 0
    s_add_u32 m0, s91, 106496
    ds_read_b128 a[32:35], v18 offset:8192
    ds_read_b128 a[36:39], v18 offset:9216
    buffer_load_dwordx4 v2, s[40:43], s76 offen offset:0 sc1 lds
    v_mfma_f32_32x32x16_bf16 v[32:47], v[132:135], a[4:7], v[32:47]
    ds_read_b128 a[40:43], v18 offset:10240
    buffer_load_dwordx4 v2, s[40:43], s76 offen offset:1024 sc1 lds
    s_waitcnt lgkmcnt(5)
    v_mfma_f32_32x32x16_bf16 v[32:47], v[136:139], a[8:11], v[32:47]
    ds_read_b128 a[44:47], v18 offset:11264
    v_mfma_f32_32x32x16_bf16 v[32:47], v[140:143], a[12:15], v[32:47]
    ds_read_b128 a[0:3], v18 offset:12288
    buffer_load_dwordx4 v2, s[40:43], s76 offen offset:2048 sc1 lds
    v_mfma_f32_32x32x16_bf16 v[32:47], v[144:147], a[16:19], v[32:47]
    ds_read_b128 a[4:7], v18 offset:13312
    buffer_load_dwordx4 v2, s[40:43], s76 offen offset:3072 sc1 lds
    v_mfma_f32_32x32x16_bf16 v[32:47], v[148:151], a[20:23], v[32:47]
    ds_read_b128 a[8:11], v18 offset:14336
    s_waitcnt lgkmcnt(5)
    v_mfma_f32_32x32x16_bf16 v[32:47], v[152:155], a[24:27], v[32:47]
    s_add_u32 m0, s91, 32768
    ds_read_b128 a[12:15], v18 offset:15360
    buffer_load_dwordx4 v2, s[40:43], s74 offen offset:0 sc1 lds
    v_mfma_f32_32x32x16_bf16 v[32:47], v[156:159], a[28:31], v[32:47]
    v_mfma_f32_32x32x16_bf16 v[32:47], v[160:163], a[32:35], v[32:47]
    buffer_load_dwordx4 v2, s[40:43], s74 offen offset:1024 sc1 lds
    v_mfma_f32_32x32x16_bf16 v[32:47], v[164:167], a[36:39], v[32:47]
    s_waitcnt vmcnt(6)
    s_waitcnt lgkmcnt(0)
    s_barrier
    v_mfma_f32_32x32x16_bf16 v[32:47], v[168:171], a[40:43], v[32:47]
    ds_read_b128 a[16:19], v18 offset:16384
    ds_read_b128 a[20:23], v18 offset:17408
    buffer_load_dwordx4 v2, s[40:43], s74 offen offset:2048 sc1 lds
    v_mfma_f32_32x32x16_bf16 v[32:47], v[172:175], a[44:47], v[32:47]
    ds_read_b128 a[24:27], v18 offset:18432
    ds_read_b128 a[28:31], v18 offset:19456
    v_mfma_f32_32x32x16_bf16 v[32:47], v[176:179], a[0:3], v[32:47]
    ds_read_b128 a[32:35], v18 offset:20480
    ds_read_b128 a[36:39], v18 offset:21504
    buffer_load_dwordx4 v2, s[40:43], s74 offen offset:3072 sc1 lds
    s_add_u32 s74, s74, 32768
    v_mfma_f32_32x32x16_bf16 v[32:47], v[180:183], a[4:7], v[32:47]
    ds_read_b128 a[40:43], v18 offset:22528
    s_waitcnt lgkmcnt(5)
    v_mfma_f32_32x32x16_bf16 v[32:47], v[184:187], a[8:11], v[32:47]
    s_add_u32 m0, s91, 49152
    ds_read_b128 a[44:47], v18 offset:23552
    s_waitcnt vmcnt(4)
    ds_read_b32 v64, v17 offset:0
    ds_read_b32 v65, v17 offset:256
    ds_read_b32 v66, v17 offset:512
    ds_read_b32 v67, v17 offset:768
    ds_read_b32 v68, v17 offset:1024
    ds_read_b32 v69, v17 offset:1280
    ds_read_b32 v70, v17 offset:1536
    ds_read_b32 v71, v17 offset:1792
    buffer_load_dwordx4 v2, s[40:43], s75 offen offset:0 sc1 lds
    v_mfma_f32_32x32x16_bf16 v[32:47], v[188:191], a[12:15], v[32:47]
    ds_read_b128 a[0:3], v18 offset:24576
    ds_read_b32 v72, v17 offset:2048
    ds_read_b32 v73, v17 offset:2304
    ds_read_b32 v74, v17 offset:2560
    ds_read_b32 v75, v17 offset:2816
    ds_read_b32 v76, v17 offset:3072
    ds_read_b32 v77, v17 offset:3328
    ds_read_b32 v78, v17 offset:3584
    ds_read_b32 v79, v17 offset:3840
    v_mfma_f32_32x32x16_bf16 v[32:47], v[192:195], a[16:19], v[32:47]
    ds_read_b128 a[4:7], v18 offset:25600
    buffer_load_dwordx4 v2, s[40:43], s75 offen offset:1024 sc1 lds
    v_mfma_f32_32x32x16_bf16 v[32:47], v[196:199], a[20:23], v[32:47]
    ds_read_b128 a[8:11], v18 offset:26624
    s_waitcnt lgkmcnt(9)
    v_add_f32 v64, v64, v72
    s_waitcnt lgkmcnt(8)
    v_add_f32 v65, v65, v73
    s_waitcnt lgkmcnt(7)
    v_add_f32 v66, v66, v74
    s_waitcnt lgkmcnt(6)
    v_add_f32 v67, v67, v75
    s_waitcnt lgkmcnt(5)
    v_add_f32 v68, v68, v76
    s_waitcnt lgkmcnt(15)
    v_mfma_f32_32x32x16_bf16 v[32:47], v[200:203], a[24:27], v[32:47]
    ds_read_b128 a[12:15], v18 offset:27648
    buffer_load_dwordx4 v2, s[40:43], s75 offen offset:2048 sc1 lds
    s_waitcnt lgkmcnt(5)
    v_add_f32 v69, v69, v77
    s_waitcnt lgkmcnt(4)
    v_add_f32 v70, v70, v78
    s_waitcnt lgkmcnt(3)
    v_add_f32 v71, v71, v79
    v_add_f32 v64, v64, v68
    v_add_f32 v65, v65, v69
    v_mfma_f32_32x32x16_bf16 v[32:47], v[204:207], a[28:31], v[32:47]
    ds_read_b128 a[16:19], v18 offset:28672
    v_add_f32 v66, v66, v70
    v_add_f32 v67, v67, v71
    v_add_f32 v64, v64, v66
    v_add_f32 v65, v65, v67
    v_add_f32 v64, v64, v65
    v_mfma_f32_32x32x16_bf16 v[32:47], v[208:211], a[32:35], v[32:47]
    ds_read_b128 a[20:23], v18 offset:29696
    buffer_load_dwordx4 v2, s[40:43], s75 offen offset:3072 sc1 lds
    s_add_u32 s75, s75, 32768
    v_mov_b32 v65, v64
    s_nop 1
    v_permlane32_swap_b32 v64, v65
    v_mul_f32 v66, 0x3b000000, v64
    v_mul_f32 v65, 0x3b000000, v65
    v_fma_f32 v65, -v66, v66, v65
    v_mfma_f32_32x32x16_bf16 v[32:47], v[212:215], a[36:39], v[32:47]
    ds_read_b128 a[24:27], v18 offset:30720
    v_max_f32 v65, 0, v65
    v_add_f32 v65, 0x3727c5ac, v65
    v_rsq_f32 v79, v65
    s_nop 0
    v_mul_f32 v68, v65, v79
    v_sub_f32 v66, 0, v66
    s_waitcnt lgkmcnt(5)
    v_mfma_f32_32x32x16_bf16 v[32:47], v[216:219], a[40:43], v[32:47]
    s_add_u32 m0, s91, 65536
    ds_read_b128 a[28:31], v18 offset:31744
    buffer_load_dwordx4 v2, s[40:43], s74 offen offset:0 sc1 lds
    v_cvt_pk_bf16_f32 v67, v66, v66
    v_and_b32 v69, 0xffff0000, v67
    v_sub_f32 v70, v66, v69
    v_cvt_pk_bf16_f32 v67, v68, v68
    v_and_b32 v71, 0xffff0000, v67
    v_mfma_f32_32x32x16_bf16 v[32:47], v[220:223], a[44:47], v[32:47]
    v_sub_f32 v72, v68, v71
    v_cvt_pk_bf16_f32 v76, v69, v70
    v_cvt_pk_bf16_f32 v77, v69, v71
    v_cvt_pk_bf16_f32 v78, v72, 0
    v_mul_f32 v79, 0x3fb8aa3b, v79
    v_mfma_f32_32x32x16_bf16 v[32:47], v[224:227], a[0:3], v[32:47]
    buffer_load_dwordx4 v2, s[40:43], s74 offen offset:1024 sc1 lds
    ds_write_b128 v16, v[76:79] offset:32768
    v_mfma_f32_32x32x16_bf16 v[32:47], v[228:231], a[4:7], v[32:47]
    s_waitcnt vmcnt(2)
    s_waitcnt lgkmcnt(0)
    s_barrier
    v_mfma_f32_32x32x16_bf16 v[32:47], v[232:235], a[8:11], v[32:47]
    ds_read_b128 a[32:35], v18 offset:32768
    ds_read_b128 a[36:39], v18 offset:33792
    s_mov_b32 s6, s81
    s_add_u32 s81, s81, 32768
    s_cmp_eq_u32 s81, 229376
    s_cmov_b32 s81, 0
    buffer_load_dwordx4 v2, s[40:43], s74 offen offset:2048 sc1 lds
    v_add_f32 v111, v118, v119
    v_cvt_pk_bf16_f32 v108, v111, v111
    v_and_b32 v29, 0xffff0000, v108
    v_sub_f32 v28, v111, v29
    v_mfma_f32_32x32x16_bf16 v[32:47], v[236:239], a[12:15], v[32:47]
    ds_read_b128 a[40:43], v18 offset:34816
    ds_read_b128 a[44:47], v18 offset:35840
    s_mov_b32 s7, s81
    s_add_u32 s81, s81, 32768
    s_cmp_eq_u32 s81, 229376
    s_cmov_b32 s81, 0
    ds_read_b128 a[224:227], v19 offset:32768
    ds_read_b128 a[228:231], v19 offset:33792
    ds_read_b128 a[232:235], v19 offset:34816
    ds_read_b128 a[236:239], v19 offset:35840
    v_cvt_pk_bf16_f32 v109, v28, 0
    v_lshl_or_b32 v109, v124, 16, v109
    v_mov_b32 v110, v124
    v_mov_b32 v111, 0
    v_mfma_f32_32x32x16_bf16 v[32:47], v[240:243], a[16:19], v[32:47]
    ds_read_b128 a[0:3], v18 offset:36864
    ds_read_b128 a[4:7], v18 offset:37888
    s_mov_b32 s8, s81
    s_add_u32 s81, s81, 32768
    s_cmp_eq_u32 s81, 229376
    s_cmov_b32 s81, 0
    buffer_load_dwordx4 v2, s[40:43], s74 offen offset:3072 sc1 lds
    s_add_u32 s74, s74, 32768
    v_mfma_f32_32x32x16_bf16 v[32:47], v[244:247], a[20:23], v[32:47]
    ds_read_b128 a[8:11], v18 offset:38912
    s_mov_b32 s9, s81
    s_add_u32 s81, s81, 32768
    s_cmp_eq_u32 s81, 229376
    s_cmov_b32 s81, 0
    s_waitcnt lgkmcnt(6)
    v_accvgpr_read_b32 v104, a224
    v_accvgpr_read_b32 v105, a225
    s_waitcnt lgkmcnt(9)
    v_mfma_f32_32x32x16_bf16 v[32:47], v[248:251], a[24:27], v[32:47]
    s_add_u32 m0, s91, 81920
    ds_read_b128 a[12:15], v18 offset:39936
    s_mov_b32 s10, s81
    s_add_u32 s81, s81, 32768
    s_cmp_eq_u32 s81, 229376
    s_cmov_b32 s81, 0
    buffer_load_dwordx4 v2, s[40:43], s75 offen offset:0 sc1 lds
    v_accvgpr_read_b32 v106, a226
    v_mfma_f32_32x32x16_bf16 v[32:47], v[252:255], a[28:31], v[32:47]
    s_nop 0
    v_mfma_f32_32x32x16_bf16 v[32:47], v[108:111], v[104:107], v[32:47]
    ds_read_b128 a[16:19], v18 offset:40960
    s_mov_b32 s14, s82
    s_add_u32 s82, s82, 2048
    s_cmp_eq_u32 s82, 14336
    s_cmov_b32 s82, 0
    v_accvgpr_read_b32 v124, a227
    v_mfma_f32_32x32x16_bf16 v[48:63], v[128:131], a[32:35], 0
    ds_read_b128 a[20:23], v18 offset:41984
    s_mov_b32 s15, s82
    s_add_u32 s82, s82, 2048
    s_cmp_eq_u32 s82, 14336
    s_cmov_b32 s82, 0
    buffer_load_dwordx4 v2, s[40:43], s75 offen offset:1024 sc1 lds
    v_mfma_f32_32x32x16_bf16 v[48:63], v[132:135], a[36:39], v[48:63]
    ds_read_b128 a[24:27], v18 offset:43008
    s_mov_b32 s16, s82
    s_add_u32 s82, s82, 2048
    s_cmp_eq_u32 s82, 14336
    s_cmov_b32 s82, 0
    s_waitcnt lgkmcnt(5)
    v_mfma_f32_32x32x16_bf16 v[48:63], v[136:139], a[40:43], v[48:63]
    ds_read_b128 a[28:31], v18 offset:44032
    s_mov_b32 s17, s82
    s_add_u32 s82, s82, 2048
    s_cmp_eq_u32 s82, 14336
    s_cmov_b32 s82, 0
    buffer_load_dwordx4 v2, s[40:43], s75 offen offset:2048 sc1 lds
    v_mfma_f32_32x32x16_bf16 v[48:63], v[140:143], a[44:47], v[48:63]
    ds_read_b128 a[32:35], v18 offset:45056
    s_mov_b32 s18, s82
    s_add_u32 s82, s82, 2048
    s_cmp_eq_u32 s82, 14336
    s_cmov_b32 s82, 0
    v_mfma_f32_32x32x16_bf16 v[48:63], v[144:147], a[0:3], v[48:63]
    ds_read_b128 a[36:39], v18 offset:46080
    s_mov_b32 s19, s82
    s_add_u32 s82, s82, 2048
    s_cmp_eq_u32 s82, 14336
    s_cmov_b32 s82, 0
    buffer_load_dwordx4 v2, s[40:43], s75 offen offset:3072 sc1 lds
    s_add_u32 s75, s75, 32768
    v_mul_f32 v32, v32, v124
    v_exp_f32 v80, v32
    v_mfma_f32_32x32x16_bf16 v[48:63], v[148:151], a[4:7], v[48:63]
    ds_read_b128 a[40:43], v18 offset:47104
    s_mov_b32 s20, s82
    s_add_u32 s82, s82, 2048
    s_cmp_eq_u32 s82, 14336
    s_cmov_b32 s82, 0
    s_waitcnt lgkmcnt(5)
    v_mfma_f32_32x32x16_bf16 v[48:63], v[152:155], a[8:11], v[48:63]
    s_add_u32 m0, s86, 0
    ds_read_b128 a[44:47], v18 offset:48128
    buffer_load_dwordx4 v12, s[28:31], s6 offen offset:0 lds
    v_mul_f32 v33, v33, v124
    v_fma_f32 v80, v80, s3, s3
    v_exp_f32 v81, v33
    v_mfma_f32_32x32x16_bf16 v[48:63], v[156:159], a[12:15], v[48:63]
    ds_read_b128 a[0:3], v18 offset:49152
    v_fma_f32 v80, v80, v80, 0.5
    v_rcp_f32 v80, v80
    v_mfma_f32_32x32x16_bf16 v[48:63], v[160:163], a[16:19], v[48:63]
    ds_read_b128 a[4:7], v18 offset:50176
    buffer_load_dwordx4 v13, s[28:31], s6 offen offset:1024 lds
    v_mul_f32 v34, v34, v124
    v_fma_f32 v81, v81, s3, s3
    v_exp_f32 v82, v34
    v_mfma_f32_32x32x16_bf16 v[48:63], v[164:167], a[20:23], v[48:63]
    ds_read_b128 a[8:11], v18 offset:51200
    v_fma_f32 v81, v81, v81, 0.5
    v_fma_f32 v32, -v80, v32, v32
    v_rcp_f32 v81, v81
    s_waitcnt lgkmcnt(5)
    v_mfma_f32_32x32x16_bf16 v[48:63], v[168:171], a[24:27], v[48:63]
    ds_read_b128 a[12:15], v18 offset:52224
    buffer_load_dwordx4 v14, s[28:31], s6 offen offset:2048 lds
    v_mul_f32 v35, v35, v124
    v_fma_f32 v82, v82, s3, s3
    v_exp_f32 v83, v35
    v_mfma_f32_32x32x16_bf16 v[48:63], v[172:175], a[28:31], v[48:63]
    ds_read_b128 a[16:19], v18 offset:53248
    v_fma_f32 v82, v82, v82, 0.5
    v_fma_f32 v33, -v81, v33, v33
    v_rcp_f32 v82, v82
    v_cvt_pk_bf16_f32 v64, v32, v33
    v_mfma_f32_32x32x16_bf16 v[48:63], v[176:179], a[32:35], v[48:63]
    ds_read_b128 a[20:23], v18 offset:54272
    buffer_load_dwordx4 v15, s[28:31], s6 offen offset:3072 lds
    v_mul_f32 v36, v36, v124
    v_fma_f32 v83, v83, s3, s3
    v_exp_f32 v80, v36
    v_mfma_f32_32x32x16_bf16 v[48:63], v[180:183], a[36:39], v[48:63]
    ds_read_b128 a[24:27], v18 offset:55296
    v_fma_f32 v83, v83, v83, 0.5
    v_fma_f32 v34, -v82, v34, v34
    v_rcp_f32 v83, v83
    s_waitcnt lgkmcnt(5)
    v_mfma_f32_32x32x16_bf16 v[48:63], v[184:187], a[40:43], v[48:63]
    s_add_u32 m0, s86, 4096
    ds_read_b128 a[28:31], v18 offset:56320
    buffer_load_dwordx4 v12, s[28:31], s7 offen offset:0 lds
    v_mul_f32 v37, v37, v124
    v_fma_f32 v80, v80, s3, s3
    v_exp_f32 v81, v37
    v_mfma_f32_32x32x16_bf16 v[48:63], v[188:191], a[44:47], v[48:63]
    ds_read_b128 a[32:35], v18 offset:57344
    v_fma_f32 v80, v80, v80, 0.5
    v_fma_f32 v35, -v83, v35, v35
    v_rcp_f32 v80, v80
    v_cvt_pk_bf16_f32 v65, v34, v35
    v_mfma_f32_32x32x16_bf16 v[48:63], v[192:195], a[0:3], v[48:63]
    ds_read_b128 a[36:39], v18 offset:58368
    buffer_load_dwordx4 v13, s[28:31], s7 offen offset:1024 lds
    v_mul_f32 v38, v38, v124
    v_fma_f32 v81, v81, s3, s3
    v_exp_f32 v82, v38
    v_mfma_f32_32x32x16_bf16 v[48:63], v[196:199], a[4:7], v[48:63]
    ds_read_b128 a[40:43], v18 offset:59392
    v_fma_f32 v81, v81, v81, 0.5
    v_fma_f32 v36, -v80, v36, v36
    v_rcp_f32 v81, v81
    s_waitcnt lgkmcnt(5)
    v_mfma_f32_32x32x16_bf16 v[48:63], v[200:203], a[8:11], v[48:63]
    ds_read_b128 a[44:47], v18 offset:60416
    buffer_load_dwordx4 v14, s[28:31], s7 offen offset:2048 lds
    v_mul_f32 v39, v39, v124
    v_fma_f32 v82, v82, s3, s3
    v_exp_f32 v83, v39
    v_mfma_f32_32x32x16_bf16 v[48:63], v[204:207], a[12:15], v[48:63]
    ds_read_b128 a[0:3], v18 offset:61440
    v_fma_f32 v82, v82, v82, 0.5
    v_fma_f32 v37, -v81, v37, v37
    v_rcp_f32 v82, v82
    v_cvt_pk_bf16_f32 v66, v36, v37
    v_mfma_f32_32x32x16_bf16 v[48:63], v[208:211], a[16:19], v[48:63]
    ds_read_b128 a[4:7], v18 offset:62464
    buffer_load_dwordx4 v15, s[28:31], s7 offen offset:3072 lds
    v_mul_f32 v40, v40, v124
    v_fma_f32 v83, v83, s3, s3
    v_exp_f32 v80, v40
    v_mfma_f32_32x32x16_bf16 v[48:63], v[212:215], a[20:23], v[48:63]
    ds_read_b128 a[8:11], v18 offset:63488
    v_fma_f32 v83, v83, v83, 0.5
    v_fma_f32 v38, -v82, v38, v38
    v_rcp_f32 v83, v83
    s_waitcnt lgkmcnt(5)
    v_mfma_f32_32x32x16_bf16 v[48:63], v[216:219], a[24:27], v[48:63]
    ds_read_b128 a[12:15], v18 offset:64512
    v_mul_f32 v41, v41, v124
    v_fma_f32 v80, v80, s3, s3
    v_exp_f32 v81, v41
    v_mfma_f32_32x32x16_bf16 v[48:63], v[220:223], a[28:31], v[48:63]
    v_fma_f32 v80, v80, v80, 0.5
    v_fma_f32 v39, -v83, v39, v39
    v_rcp_f32 v80, v80
    v_cvt_pk_bf16_f32 v67, v38, v39
    v_mfma_f32_32x32x16_bf16 v[48:63], v[224:227], a[32:35], v[48:63]
    v_mul_f32 v42, v42, v124
    v_fma_f32 v81, v81, s3, s3
    v_exp_f32 v82, v42
    v_mfma_f32_32x32x16_bf16 v[48:63], v[228:231], a[36:39], v[48:63]
    v_fma_f32 v81, v81, v81, 0.5
    v_fma_f32 v40, -v80, v40, v40
    v_rcp_f32 v81, v81
    s_waitcnt vmcnt(8)
    s_waitcnt lgkmcnt(0)
    s_barrier
    v_mfma_f32_32x32x16_bf16 v[48:63], v[232:235], a[40:43], v[48:63]
    s_add_u32 m0, s91, 98304
    ds_read_b128 a[16:19], v19 offset:0
    ds_read_b128 a[20:23], v19 offset:1024
    buffer_load_dwordx4 v2, s[40:43], s74 offen offset:0 sc1 lds
    v_mul_f32 v43, v43, v124
    v_fma_f32 v82, v82, s3, s3
    v_exp_f32 v83, v43
    v_mfma_f32_32x32x16_bf16 v[48:63], v[236:239], a[44:47], v[48:63]
    ds_read_b128 a[24:27], v19 offset:2048
    ds_read_b128 a[28:31], v19 offset:3072
    v_fma_f32 v82, v82, v82, 0.5
    v_fma_f32 v41, -v81, v41, v41
    v_rcp_f32 v82, v82
    v_cvt_pk_bf16_f32 v68, v40, v41
    v_mfma_f32_32x32x16_bf16 v[48:63], v[240:243], a[0:3], v[48:63]
    ds_read_b128 a[32:35], v19 offset:4096
    ds_read_b128 a[36:39], v19 offset:5120
    buffer_load_dwordx4 v2, s[40:43], s74 offen offset:1024 sc1 lds
    v_mul_f32 v44, v44, v124
    v_fma_f32 v83, v83, s3, s3
    v_exp_f32 v80, v44
    v_mfma_f32_32x32x16_bf16 v[48:63], v[244:247], a[4:7], v[48:63]
    ds_read_b128 a[40:43], v19 offset:6144
    v_fma_f32 v83, v83, v83, 0.5
    v_fma_f32 v42, -v82, v42, v42
    v_rcp_f32 v83, v83
    v_accvgpr_read_b32 v104, a228
    v_accvgpr_read_b32 v105, a229
    s_waitcnt lgkmcnt(5)
    v_mfma_f32_32x32x16_bf16 v[48:63], v[248:251], a[8:11], v[48:63]
    ds_read_b128 a[44:47], v19 offset:7168
    buffer_load_dwordx4 v2, s[40:43], s74 offen offset:2048 sc1 lds
    v_mul_f32 v45, v45, v124
    v_fma_f32 v80, v80, s3, s3
    v_exp_f32 v81, v45
    v_accvgpr_read_b32 v106, a230
    v_mfma_f32_32x32x16_bf16 v[48:63], v[252:255], a[12:15], v[48:63]
    s_nop 0
    v_mfma_f32_32x32x16_bf16 v[48:63], v[108:111], v[104:107], v[48:63]
    ds_read_b128 a[0:3], v19 offset:8192
    v_fma_f32 v80, v80, v80, 0.5
    v_fma_f32 v43, -v83, v43, v43
    v_rcp_f32 v80, v80
    v_cvt_pk_bf16_f32 v69, v42, v43
    v_accvgpr_read_b32 v125, a231
    v_mfma_f32_32x32x16_bf16 v[88:103], v[128:131], a[16:19], 0
    ds_read_b128 a[4:7], v19 offset:9216
    buffer_load_dwordx4 v2, s[40:43], s74 offen offset:3072 sc1 lds
    s_add_u32 s74, s74, 32768
    v_mul_f32 v46, v46, v124
    v_fma_f32 v81, v81, s3, s3
    v_exp_f32 v82, v46
    v_mfma_f32_32x32x16_bf16 v[88:103], v[132:135], a[20:23], v[88:103]
    ds_read_b128 a[8:11], v19 offset:10240
    v_fma_f32 v81, v81, v81, 0.5
    v_fma_f32 v44, -v80, v44, v44
    v_rcp_f32 v81, v81
    s_waitcnt lgkmcnt(5)
    v_mfma_f32_32x32x16_bf16 v[88:103], v[136:139], a[24:27], v[88:103]
    s_add_u32 m0, s91, 114688
    ds_read_b128 a[12:15], v19 offset:11264
    buffer_load_dwordx4 v2, s[40:43], s75 offen offset:0 sc1 lds
    v_mul_f32 v47, v47, v124
    v_fma_f32 v82, v82, s3, s3
    v_exp_f32 v83, v47
    v_mfma_f32_32x32x16_bf16 v[88:103], v[140:143], a[28:31], v[88:103]
    ds_read_b128 a[16:19], v19 offset:12288
    v_fma_f32 v82, v82, v82, 0.5
    v_fma_f32 v45, -v81, v45, v45
    v_rcp_f32 v82, v82
    v_cvt_pk_bf16_f32 v70, v44, v45
    v_mfma_f32_32x32x16_bf16 v[88:103], v[144:147], a[32:35], v[88:103]
    ds_read_b128 a[20:23], v19 offset:13312
    buffer_load_dwordx4 v2, s[40:43], s75 offen offset:1024 sc1 lds
    v_mul_f32 v48, v48, v125
    v_fma_f32 v83, v83, s3, s3
    v_exp_f32 v80, v48
    v_mfma_f32_32x32x16_bf16 v[88:103], v[148:151], a[36:39], v[88:103]
    ds_read_b128 a[24:27], v19 offset:14336
    v_fma_f32 v83, v83, v83, 0.5
    v_fma_f32 v46, -v82, v46, v46
    v_rcp_f32 v83, v83
    s_waitcnt lgkmcnt(5)
    v_mfma_f32_32x32x16_bf16 v[88:103], v[152:155], a[40:43], v[88:103]
    ds_read_b128 a[28:31], v19 offset:15360
    buffer_load_dwordx4 v2, s[40:43], s75 offen offset:2048 sc1 lds
    v_mul_f32 v49, v49, v125
    v_fma_f32 v80, v80, s3, s3
    v_exp_f32 v81, v49
    v_mfma_f32_32x32x16_bf16 v[88:103], v[156:159], a[44:47], v[88:103]
    ds_read_b128 a[32:35], v19 offset:16384
    v_fma_f32 v80, v80, v80, 0.5
    v_fma_f32 v47, -v83, v47, v47
    v_rcp_f32 v80, v80
    v_cvt_pk_bf16_f32 v71, v46, v47
    v_mfma_f32_32x32x16_bf16 v[88:103], v[160:163], a[0:3], v[88:103]
    ds_read_b128 a[36:39], v19 offset:17408
    buffer_load_dwordx4 v2, s[40:43], s75 offen offset:3072 sc1 lds
    s_add_u32 s75, s75, 32768
    v_mul_f32 v50, v50, v125
    v_fma_f32 v81, v81, s3, s3
    v_exp_f32 v82, v50
    v_mfma_f32_32x32x16_bf16 v[88:103], v[164:167], a[4:7], v[88:103]
    ds_read_b128 a[40:43], v19 offset:18432
    v_fma_f32 v81, v81, v81, 0.5
    v_fma_f32 v48, -v80, v48, v48
    v_rcp_f32 v81, v81
    s_waitcnt lgkmcnt(5)
    v_mfma_f32_32x32x16_bf16 v[88:103], v[168:171], a[8:11], v[88:103]
    ds_read_b128 a[44:47], v19 offset:19456
    buffer_store_dwordx4 v[64:67], v2, s[40:43], s77 offen offset:0 sc1
    buffer_store_dwordx4 v[68:71], v2, s[40:43], s77 offen offset:1024 sc1
    s_add_u32 s77, s77, 114688
    v_mul_f32 v51, v51, v125
    v_fma_f32 v82, v82, s3, s3
    v_exp_f32 v83, v51
    v_mfma_f32_32x32x16_bf16 v[88:103], v[172:175], a[12:15], v[88:103]
    ds_read_b128 a[0:3], v19 offset:20480
    v_fma_f32 v82, v82, v82, 0.5
    v_fma_f32 v49, -v81, v49, v49
    v_rcp_f32 v82, v82
    v_cvt_pk_bf16_f32 v72, v48, v49
    v_mfma_f32_32x32x16_bf16 v[88:103], v[176:179], a[16:19], v[88:103]
    s_add_u32 m0, s86, 32768
    ds_read_b128 a[4:7], v19 offset:21504
    buffer_load_dwordx4 v12, s[28:31], s8 offen offset:0 lds
    v_mul_f32 v52, v52, v125
    v_fma_f32 v83, v83, s3, s3
    v_exp_f32 v80, v52
    v_mfma_f32_32x32x16_bf16 v[88:103], v[180:183], a[20:23], v[88:103]
    ds_read_b128 a[8:11], v19 offset:22528
    v_fma_f32 v83, v83, v83, 0.5
    v_fma_f32 v50, -v82, v50, v50
    v_rcp_f32 v83, v83
    s_waitcnt lgkmcnt(5)
    v_mfma_f32_32x32x16_bf16 v[88:103], v[184:187], a[24:27], v[88:103]
    ds_read_b128 a[12:15], v19 offset:23552
    buffer_load_dwordx4 v13, s[28:31], s8 offen offset:1024 lds
    v_mul_f32 v53, v53, v125
    v_fma_f32 v80, v80, s3, s3
    v_exp_f32 v81, v53
    v_mfma_f32_32x32x16_bf16 v[88:103], v[188:191], a[28:31], v[88:103]
    ds_read_b128 a[16:19], v19 offset:24576
    v_fma_f32 v80, v80, v80, 0.5
    v_fma_f32 v51, -v83, v51, v51
    v_rcp_f32 v80, v80
    v_cvt_pk_bf16_f32 v73, v50, v51
    v_mfma_f32_32x32x16_bf16 v[88:103], v[192:195], a[32:35], v[88:103]
    ds_read_b128 a[20:23], v19 offset:25600
    buffer_load_dwordx4 v14, s[28:31], s8 offen offset:2048 lds
    v_mul_f32 v54, v54, v125
    v_fma_f32 v81, v81, s3, s3
    v_exp_f32 v82, v54
    v_mfma_f32_32x32x16_bf16 v[88:103], v[196:199], a[36:39], v[88:103]
    ds_read_b128 a[24:27], v19 offset:26624
    v_fma_f32 v81, v81, v81, 0.5
    v_fma_f32 v52, -v80, v52, v52
    v_rcp_f32 v81, v81
    s_waitcnt lgkmcnt(5)
    v_mfma_f32_32x32x16_bf16 v[88:103], v[200:203], a[40:43], v[88:103]
    ds_read_b128 a[28:31], v19 offset:27648
    buffer_load_dwordx4 v15, s[28:31], s8 offen offset:3072 lds
    v_mul_f32 v55, v55, v125
    v_fma_f32 v82, v82, s3, s3
    v_exp_f32 v83, v55
    v_mfma_f32_32x32x16_bf16 v[88:103], v[204:207], a[44:47], v[88:103]
    ds_read_b128 a[32:35], v19 offset:28672
    v_fma_f32 v82, v82, v82, 0.5
    v_fma_f32 v53, -v81, v53, v53
    v_rcp_f32 v82, v82
    v_cvt_pk_bf16_f32 v74, v52, v53
    v_mfma_f32_32x32x16_bf16 v[88:103], v[208:211], a[0:3], v[88:103]
    s_add_u32 m0, s86, 36864
    ds_read_b128 a[36:39], v19 offset:29696
    buffer_load_dwordx4 v12, s[28:31], s9 offen offset:0 lds
    v_mul_f32 v56, v56, v125
    v_fma_f32 v83, v83, s3, s3
    v_exp_f32 v80, v56
    v_mfma_f32_32x32x16_bf16 v[88:103], v[212:215], a[4:7], v[88:103]
    ds_read_b128 a[40:43], v19 offset:30720
    v_fma_f32 v83, v83, v83, 0.5
    v_fma_f32 v54, -v82, v54, v54
    v_rcp_f32 v83, v83
    s_waitcnt lgkmcnt(5)
    v_mfma_f32_32x32x16_bf16 v[88:103], v[216:219], a[8:11], v[88:103]
    ds_read_b128 a[44:47], v19 offset:31744
    buffer_load_dwordx4 v13, s[28:31], s9 offen offset:1024 lds
    v_mul_f32 v57, v57, v125
    v_fma_f32 v80, v80, s3, s3
    v_exp_f32 v81, v57
    v_mfma_f32_32x32x16_bf16 v[88:103], v[220:223], a[12:15], v[88:103]
    v_fma_f32 v80, v80, v80, 0.5
    v_fma_f32 v55, -v83, v55, v55
    v_rcp_f32 v80, v80
    v_cvt_pk_bf16_f32 v75, v54, v55
    v_mfma_f32_32x32x16_bf16 v[88:103], v[224:227], a[16:19], v[88:103]
    buffer_load_dwordx4 v14, s[28:31], s9 offen offset:2048 lds
    v_mul_f32 v58, v58, v125
    v_fma_f32 v81, v81, s3, s3
    v_exp_f32 v82, v58
    v_mfma_f32_32x32x16_bf16 v[88:103], v[228:231], a[20:23], v[88:103]
    v_fma_f32 v81, v81, v81, 0.5
    v_fma_f32 v56, -v80, v56, v56
    v_rcp_f32 v81, v81
    s_waitcnt vmcnt(9)
    s_waitcnt lgkmcnt(0)
    s_barrier
    v_mfma_f32_32x32x16_bf16 v[88:103], v[232:235], a[24:27], v[88:103]
    ds_read_b128 a[0:3], v19 offset:32768
    ds_read_b128 a[4:7], v19 offset:33792
    buffer_load_dwordx4 v15, s[28:31], s9 offen offset:3072 lds
    v_mul_f32 v59, v59, v125
    v_fma_f32 v82, v82, s3, s3
    v_exp_f32 v83, v59
    v_mfma_f32_32x32x16_bf16 v[88:103], v[236:239], a[28:31], v[88:103]
    ds_read_b128 a[8:11], v19 offset:34816
    ds_read_b128 a[12:15], v19 offset:35840
    v_fma_f32 v82, v82, v82, 0.5
    v_fma_f32 v57, -v81, v57, v57
    v_rcp_f32 v82, v82
    v_cvt_pk_bf16_f32 v76, v56, v57
    v_mfma_f32_32x32x16_bf16 v[88:103], v[240:243], a[32:35], v[88:103]
    s_add_u32 m0, s86, 65536
    ds_read_b128 a[16:19], v19 offset:36864
    ds_read_b128 a[20:23], v19 offset:37888
    buffer_load_dwordx4 v12, s[28:31], s10 offen offset:0 lds
    v_mul_f32 v60, v60, v125
    v_fma_f32 v83, v83, s3, s3
    v_exp_f32 v80, v60
    v_mfma_f32_32x32x16_bf16 v[88:103], v[244:247], a[36:39], v[88:103]
    ds_read_b128 a[24:27], v19 offset:38912
    v_fma_f32 v83, v83, v83, 0.5
    v_fma_f32 v58, -v82, v58, v58
    v_rcp_f32 v83, v83
    v_accvgpr_read_b32 v104, a232
    v_accvgpr_read_b32 v105, a233
    s_waitcnt lgkmcnt(5)
    v_mfma_f32_32x32x16_bf16 v[88:103], v[248:251], a[40:43], v[88:103]
    ds_read_b128 a[28:31], v19 offset:39936
    buffer_load_dwordx4 v13, s[28:31], s10 offen offset:1024 lds
    v_mul_f32 v61, v61, v125
    v_fma_f32 v80, v80, s3, s3
    v_exp_f32 v81, v61
    v_accvgpr_read_b32 v106, a234
    v_mfma_f32_32x32x16_bf16 v[88:103], v[252:255], a[44:47], v[88:103]
    s_nop 0
    v_mfma_f32_32x32x16_bf16 v[88:103], v[108:111], v[104:107], v[88:103]
    ds_read_b128 a[32:35], v19 offset:40960
    v_fma_f32 v80, v80, v80, 0.5
    v_fma_f32 v59, -v83, v59, v59
    v_rcp_f32 v80, v80
    v_cvt_pk_bf16_f32 v77, v58, v59
    v_accvgpr_read_b32 v124, a235
    v_mfma_f32_32x32x16_bf16 v[32:47], v[128:131], a[0:3], 0
    ds_read_b128 a[36:39], v19 offset:41984
    buffer_load_dwordx4 v14, s[28:31], s10 offen offset:2048 lds
    v_mul_f32 v62, v62, v125
    v_fma_f32 v81, v81, s3, s3
    v_exp_f32 v82, v62
    v_mfma_f32_32x32x16_bf16 v[32:47], v[132:135], a[4:7], v[32:47]
    ds_read_b128 a[40:43], v19 offset:43008
    v_fma_f32 v81, v81, v81, 0.5
    v_fma_f32 v60, -v80, v60, v60
    v_rcp_f32 v81, v81
    s_waitcnt lgkmcnt(5)
    v_mfma_f32_32x32x16_bf16 v[32:47], v[136:139], a[8:11], v[32:47]
    ds_read_b128 a[44:47], v19 offset:44032
    buffer_load_dwordx4 v15, s[28:31], s10 offen offset:3072 lds
    v_mul_f32 v63, v63, v125
    v_fma_f32 v82, v82, s3, s3
    v_exp_f32 v83, v63
    v_mfma_f32_32x32x16_bf16 v[32:47], v[140:143], a[12:15], v[32:47]
    ds_read_b128 a[0:3], v19 offset:45056
    v_fma_f32 v82, v82, v82, 0.5
    v_fma_f32 v61, -v81, v61, v61
    v_rcp_f32 v82, v82
    v_cvt_pk_bf16_f32 v78, v60, v61
    s_waitcnt vmcnt(12)
    s_barrier
    s_cmp_lg_u32 s46, 0
    s_cbranch_scc1 L_noarr_17
    s_add_u32 s88, s85, 98304
    s_mov_b64 exec, 1
    s_cmp_lg_u32 s60, 0
    s_cbranch_scc1 L_noarr_17_l
    buffer_store_dword v121, v3, s[40:43], s88 offen sc1
    s_branch L_noarr_17_e
L_noarr_17_l:
    buffer_store_dword v121, v3, s[40:43], s88 offen
L_noarr_17_e:
    s_mov_b64 exec, -1
L_noarr_17:
    v_mfma_f32_32x32x16_bf16 v[32:47], v[144:147], a[16:19], v[32:47]
    ds_read_b128 a[4:7], v19 offset:46080
    v_mul_f32 v88, v88, v124
    v_fma_f32 v83, v83, s3, s3
    v_exp_f32 v80, v88
    v_mfma_f32_32x32x16_bf16 v[32:47], v[148:151], a[20:23], v[32:47]
    ds_read_b128 a[8:11], v19 offset:47104
    v_fma_f32 v83, v83, v83, 0.5
    v_fma_f32 v62, -v82, v62, v62
    v_rcp_f32 v83, v83
    s_waitcnt lgkmcnt(5)
    v_mfma_f32_32x32x16_bf16 v[32:47], v[152:155], a[24:27], v[32:47]
    ds_read_b128 a[12:15], v19 offset:48128
    v_mul_f32 v89, v89, v124
    v_fma_f32 v80, v80, s3, s3
    v_exp_f32 v81, v89
    v_mfma_f32_32x32x16_bf16 v[32:47], v[156:159], a[28:31], v[32:47]
    ds_read_b128 a[16:19], v19 offset:49152
    v_fma_f32 v80, v80, v80, 0.5
    v_fma_f32 v63, -v83, v63, v63
    v_rcp_f32 v80, v80
    v_cvt_pk_bf16_f32 v79, v62, v63
    v_mfma_f32_32x32x16_bf16 v[32:47], v[160:163], a[32:35], v[32:47]
    ds_read_b128 a[20:23], v19 offset:50176
    buffer_store_dwordx4 v[72:75], v2, s[40:43], s77 offen offset:0 sc1
    buffer_store_dwordx4 v[76:79], v2, s[40:43], s77 offen offset:1024 sc1
    s_add_u32 s77, s77, 114688
    v_mul_f32 v90, v90, v124
    v_fma_f32 v81, v81, s3, s3
    v_exp_f32 v82, v90
    v_mfma_f32_32x32x16_bf16 v[32:47], v[164:167], a[36:39], v[32:47]
    ds_read_b128 a[24:27], v19 offset:51200
    v_fma_f32 v81, v81, v81, 0.5
    v_fma_f32 v88, -v80, v88, v88
    v_rcp_f32 v81, v81
    s_waitcnt lgkmcnt(5)
    v_mfma_f32_32x32x16_bf16 v[32:47], v[168:171], a[40:43], v[32:47]
    ds_read_b128 a[28:31], v19 offset:52224
    v_mul_f32 v91, v91, v124
    v_fma_f32 v82, v82, s3, s3
    v_exp_f32 v83, v91
    v_mfma_f32_32x32x16_bf16 v[32:47], v[172:175], a[44:47], v[32:47]
    ds_read_b128 a[32:35], v19 offset:53248
    v_fma_f32 v82, v82, v82, 0.5
    v_fma_f32 v89, -v81, v89, v89
    v_rcp_f32 v82, v82
    v_cvt_pk_bf16_f32 v64, v88, v89
    v_mfma_f32_32x32x16_bf16 v[32:47], v[176:179], a[0:3], v[32:47]
    ds_read_b128 a[36:39], v19 offset:54272
    v_mul_f32 v92, v92, v124
    v_fma_f32 v83, v83, s3, s3
    v_exp_f32 v80, v92
    v_mfma_f32_32x32x16_bf16 v[32:47], v[180:183], a[4:7], v[32:47]
    ds_read_b128 a[40:43], v19 offset:55296
    v_fma_f32 v83, v83, v83, 0.5
    v_fma_f32 v90, -v82, v90, v90
    v_rcp_f32 v83, v83
    s_waitcnt lgkmcnt(5)
    v_mfma_f32_32x32x16_bf16 v[32:47], v[184:187], a[8:11], v[32:47]
    ds_read_b128 a[44:47], v19 offset:56320
    v_mul_f32 v93, v93, v124
    v_fma_f32 v80, v80, s3, s3
    v_exp_f32 v81, v93
    v_mfma_f32_32x32x16_bf16 v[32:47], v[188:191], a[12:15], v[32:47]
    ds_read_b128 a[0:3], v19 offset:57344
    v_fma_f32 v80, v80, v80, 0.5
    v_fma_f32 v91, -v83, v91, v91
    v_rcp_f32 v80, v80
    v_cvt_pk_bf16_f32 v65, v90, v91
    v_mfma_f32_32x32x16_bf16 v[32:47], v[192:195], a[16:19], v[32:47]
    ds_read_b128 a[4:7], v19 offset:58368
    v_mul_f32 v94, v94, v124
    v_fma_f32 v81, v81, s3, s3
    v_exp_f32 v82, v94
    v_mfma_f32_32x32x16_bf16 v[32:47], v[196:199], a[20:23], v[32:47]
    ds_read_b128 a[8:11], v19 offset:59392
    v_fma_f32 v81, v81, v81, 0.5
    v_fma_f32 v92, -v80, v92, v92
    v_rcp_f32 v81, v81
    s_waitcnt lgkmcnt(5)
    v_mfma_f32_32x32x16_bf16 v[32:47], v[200:203], a[24:27], v[32:47]
    ds_read_b128 a[12:15], v19 offset:60416
    v_mul_f32 v95, v95, v124
    v_fma_f32 v82, v82, s3, s3
    v_exp_f32 v83, v95
    v_mfma_f32_32x32x16_bf16 v[32:47], v[204:207], a[28:31], v[32:47]
    ds_read_b128 a[16:19], v19 offset:61440
    v_fma_f32 v82, v82, v82, 0.5
    v_fma_f32 v93, -v81, v93, v93
    v_rcp_f32 v82, v82
    v_cvt_pk_bf16_f32 v66, v92, v93
    v_mfma_f32_32x32x16_bf16 v[32:47], v[208:211], a[32:35], v[32:47]
    ds_read_b128 a[20:23], v19 offset:62464
    v_mul_f32 v96, v96, v124
    v_fma_f32 v83, v83, s3, s3
    v_exp_f32 v80, v96
    v_mfma_f32_32x32x16_bf16 v[32:47], v[212:215], a[36:39], v[32:47]
    ds_read_b128 a[24:27], v19 offset:63488
    v_fma_f32 v83, v83, v83, 0.5
    v_fma_f32 v94, -v82, v94, v94
    v_rcp_f32 v83, v83
    s_waitcnt lgkmcnt(5)
    v_mfma_f32_32x32x16_bf16 v[32:47], v[216:219], a[40:43], v[32:47]
    ds_read_b128 a[28:31], v19 offset:64512
    v_mul_f32 v97, v97, v124
    v_fma_f32 v80, v80, s3, s3
    v_exp_f32 v81, v97
    v_mfma_f32_32x32x16_bf16 v[32:47], v[220:223], a[44:47], v[32:47]
    v_fma_f32 v80, v80, v80, 0.5
    v_fma_f32 v95, -v83, v95, v95
    v_rcp_f32 v80, v80
    v_cvt_pk_bf16_f32 v67, v94, v95
    v_mfma_f32_32x32x16_bf16 v[32:47], v[224:227], a[0:3], v[32:47]
    v_mul_f32 v98, v98, v124
    v_fma_f32 v81, v81, s3, s3
    v_exp_f32 v82, v98
    v_mfma_f32_32x32x16_bf16 v[32:47], v[228:231], a[4:7], v[32:47]
    v_fma_f32 v81, v81, v81, 0.5
    v_fma_f32 v96, -v80, v96, v96
    v_rcp_f32 v81, v81
    s_cmp_lg_u32 s46, 3
    s_cbranch_scc1 L_noci_18
    s_add_u32 s88, s67, 98304
    s_mov_b64 exec, 0xffff
    buffer_load_dword v113, v3, s[40:43], s88 offen sc1
    s_mov_b64 exec, -1
L_noci_18:
    s_waitcnt lgkmcnt(2)
    v_mfma_f32_32x32x16_bf16 v[32:47], v[232:235], a[8:11], v[32:47]
    v_mul_f32 v99, v99, v124
    v_fma_f32 v82, v82, s3, s3
    v_exp_f32 v83, v99
    v_mfma_f32_32x32x16_bf16 v[32:47], v[236:239], a[12:15], v[32:47]
    v_fma_f32 v82, v82, v82, 0.5
    v_fma_f32 v97, -v81, v97, v97
    v_rcp_f32 v82, v82
    v_cvt_pk_bf16_f32 v68, v96, v97
    v_mfma_f32_32x32x16_bf16 v[32:47], v[240:243], a[16:19], v[32:47]
    v_mul_f32 v100, v100, v124
    v_fma_f32 v83, v83, s3, s3
    v_exp_f32 v80, v100
    v_mfma_f32_32x32x16_bf16 v[32:47], v[244:247], a[20:23], v[32:47]
    v_fma_f32 v83, v83, v83, 0.5
    v_fma_f32 v98, -v82, v98, v98
    v_rcp_f32 v83, v83
    v_accvgpr_read_b32 v104, a236
    v_accvgpr_read_b32 v105, a237
    s_waitcnt lgkmcnt(0)
    v_mfma_f32_32x32x16_bf16 v[32:47], v[248:251], a[24:27], v[32:47]
    v_mul_f32 v101, v101, v124
    v_fma_f32 v80, v80, s3, s3
    v_exp_f32 v81, v101
    v_accvgpr_read_b32 v106, a238
    s_cmp_lg_u32 s46, 3
    s_cbranch_scc1 L_chk_19_z
    s_mov_b64 exec, 0x3fff
    s_waitcnt vmcnt(0)
    v_cmp_ne_u32 vcc, s36, v113
    s_nop 0
    s_cbranch_vccz L_chk_19_x
    s_add_u32 s88, s67, 98304
L_chk_19:
    buffer_load_dword v113, v3, s[40:43], s88 offen sc1
    s_add_u32 s59, s59, 1
    s_cmp_gt_u32 s59, 400000
    s_cbranch_scc1 L_chk_19_y
    s_waitcnt vmcnt(0)
    v_cmp_ne_u32 vcc, s36, v113
    s_nop 0
    s_cbranch_vccnz L_chk_19
L_chk_19_y:
    s_waitcnt vmcnt(0)
L_chk_19_x:
    s_mov_b64 exec, -1
L_chk_19_z:
    s_barrier
    v_mfma_f32_32x32x16_bf16 v[32:47], v[252:255], a[28:31], v[32:47]
    v_mfma_f32_32x32x16_bf16 v[32:47], v[108:111], v[104:107], v[32:47]
    buffer_load_dwordx4 a[48:51], v6, s[40:43], s14 offen offset:0 sc1
    buffer_load_dwordx4 a[52:55], v6, s[40:43], s14 offen offset:1024 sc1
    v_fma_f32 v80, v80, v80, 0.5
    v_fma_f32 v99, -v83, v99, v99
    v_rcp_f32 v80, v80
    v_cvt_pk_bf16_f32 v69, v98, v99
    v_accvgpr_read_b32 v125, a239
    buffer_load_dwordx4 a[56:59], v6, s[40:43], s15 offen offset:0 sc1
    v_mul_f32 v102, v102, v124
    v_fma_f32 v81, v81, s3, s3
    v_exp_f32 v82, v102
    v_fma_f32 v81, v81, v81, 0.5
    buffer_load_dwordx4 a[60:63], v6, s[40:43], s15 offen offset:1024 sc1
    s_waitcnt vmcnt(4)
    s_barrier
    s_cmp_lg_u32 s46, 0
    s_cbranch_scc1 L_noarr_20
    s_add_u32 s88, s85, 98432
    s_mov_b64 exec, 1
    s_cmp_lg_u32 s60, 0
    s_cbranch_scc1 L_noarr_20_l
    buffer_store_dword v121, v3, s[40:43], s88 offen sc1
    s_branch L_noarr_20_e
L_noarr_20_l:
    buffer_store_dword v121, v3, s[40:43], s88 offen
L_noarr_20_e:
    s_mov_b64 exec, -1
L_noarr_20:
    v_fma_f32 v100, -v80, v100, v100
    v_rcp_f32 v81, v81
    v_mul_f32 v103, v103, v124
    v_fma_f32 v82, v82, s3, s3
    buffer_load_dwordx4 a[64:67], v6, s[40:43], s16 offen offset:0 sc1
    v_exp_f32 v83, v103
    v_fma_f32 v82, v82, v82, 0.5
    v_fma_f32 v101, -v81, v101, v101
    v_rcp_f32 v82, v82
    buffer_load_dwordx4 a[68:71], v6, s[40:43], s16 offen offset:1024 sc1
    v_cvt_pk_bf16_f32 v70, v100, v101
    v_fma_f32 v83, v83, s3, s3
    v_fma_f32 v83, v83, v83, 0.5
    v_fma_f32 v102, -v82, v102, v102
    buffer_load_dwordx4 a[72:75], v6, s[40:43], s17 offen offset:0 sc1
    v_rcp_f32 v83, v83
    s_nop 0
    v_fma_f32 v103, -v83, v103, v103
    v_cvt_pk_bf16_f32 v71, v102, v103
    v_mov_b32 v28, s3
    buffer_load_dwordx4 a[76:79], v6, s[40:43], s17 offen offset:1024 sc1
    v_mov_b32 v29, 0.5
    v_pk_mul_f32 v[32:33], v[32:33], v[124:125] op_sel:[0,1] op_sel_hi:[1,1]
    v_pk_mul_f32 v[34:35], v[34:35], v[124:125] op_sel:[0,1] op_sel_hi:[1,1]
    v_pk_mul_f32 v[36:37], v[36:37], v[124:125] op_sel:[0,1] op_sel_hi:[1,1]
    v_pk_mul_f32 v[38:39], v[38:39], v[124:125] op_sel:[0,1] op_sel_hi:[1,1]
    v_exp_f32 v88, v32
    v_exp_f32 v89, v33
    v_exp_f32 v90, v34
    buffer_store_dwordx4 v[64:67], v2, s[40:43], s77 offen offset:0 sc1
    buffer_store_dwordx4 v[68:71], v2, s[40:43], s77 offen offset:1024 sc1
    s_add_u32 s77, s77, 114688
    v_exp_f32 v91, v35
    v_exp_f32 v92, v36
    v_exp_f32 v93, v37
    v_exp_f32 v94, v38
    v_exp_f32 v95, v39
    v_pk_fma_f32 v[88:89], v[88:89], v[28:29], v[28:29] op_sel_hi:[1,0,0]
    v_pk_fma_f32 v[90:91], v[90:91], v[28:29], v[28:29] op_sel_hi:[1,0,0]
    v_pk_fma_f32 v[92:93], v[92:93], v[28:29], v[28:29] op_sel_hi:[1,0,0]
    v_pk_fma_f32 v[94:95], v[94:95], v[28:29], v[28:29] op_sel_hi:[1,0,0]
    v_pk_fma_f32 v[88:89], v[88:89], v[88:89], v[28:29] op_sel:[0,0,1] op_sel_hi:[1,1,1]
    v_pk_fma_f32 v[90:91], v[90:91], v[90:91], v[28:29] op_sel:[0,0,1] op_sel_hi:[1,1,1]
    v_pk_fma_f32 v[92:93], v[92:93], v[92:93], v[28:29] op_sel:[0,0,1] op_sel_hi:[1,1,1]
    v_pk_fma_f32 v[94:95], v[94:95], v[94:95], v[28:29] op_sel:[0,0,1] op_sel_hi:[1,1,1]
    v_rcp_f32 v88, v88
    v_rcp_f32 v89, v89
    v_rcp_f32 v90, v90
    v_rcp_f32 v91, v91
    v_rcp_f32 v92, v92
    v_rcp_f32 v93, v93
    v_rcp_f32 v94, v94
    v_rcp_f32 v95, v95
    v_pk_fma_f32 v[32:33], v[88:89], v[32:33], v[32:33] neg_lo:[1,0,0] neg_hi:[1,0,0]
    v_pk_fma_f32 v[34:35], v[90:91], v[34:35], v[34:35] neg_lo:[1,0,0] neg_hi:[1,0,0]
    v_pk_fma_f32 v[36:37], v[92:93], v[36:37], v[36:37] neg_lo:[1,0,0] neg_hi:[1,0,0]
    v_pk_fma_f32 v[38:39], v[94:95], v[38:39], v[38:39] neg_lo:[1,0,0] neg_hi:[1,0,0]
    v_cvt_pk_bf16_f32 v72, v32, v33
    v_cvt_pk_bf16_f32 v73, v34, v35
    v_cvt_pk_bf16_f32 v74, v36, v37
    v_cvt_pk_bf16_f32 v75, v38, v39
    v_pk_mul_f32 v[40:41], v[40:41], v[124:125] op_sel:[0,1] op_sel_hi:[1,1]
    v_pk_mul_f32 v[42:43], v[42:43], v[124:125] op_sel:[0,1] op_sel_hi:[1,1]
    v_pk_mul_f32 v[44:45], v[44:45], v[124:125] op_sel:[0,1] op_sel_hi:[1,1]
    v_pk_mul_f32 v[46:47], v[46:47], v[124:125] op_sel:[0,1] op_sel_hi:[1,1]
    v_exp_f32 v96, v40
    v_exp_f32 v97, v41
    v_exp_f32 v98, v42
    v_exp_f32 v99, v43
    v_exp_f32 v100, v44
    v_exp_f32 v101, v45
    v_exp_f32 v102, v46
    v_exp_f32 v103, v47
    v_pk_fma_f32 v[96:97], v[96:97], v[28:29], v[28:29] op_sel_hi:[1,0,0]
    v_pk_fma_f32 v[98:99], v[98:99], v[28:29], v[28:29] op_sel_hi:[1,0,0]
    v_pk_fma_f32 v[100:101], v[100:101], v[28:29], v[28:29] op_sel_hi:[1,0,0]
    v_pk_fma_f32 v[102:103], v[102:103], v[28:29], v[28:29] op_sel_hi:[1,0,0]
    v_pk_fma_f32 v[96:97], v[96:97], v[96:97], v[28:29] op_sel:[0,0,1] op_sel_hi:[1,1,1]
    v_pk_fma_f32 v[98:99], v[98:99], v[98:99], v[28:29] op_sel:[0,0,1] op_sel_hi:[1,1,1]
    v_pk_fma_f32 v[100:101], v[100:101], v[100:101], v[28:29] op_sel:[0,0,1] op_sel_hi:[1,1,1]
    v_pk_fma_f32 v[102:103], v[102:103], v[102:103], v[28:29] op_sel:[0,0,1] op_sel_hi:[1,1,1]
    v_rcp_f32 v96, v96
    v_rcp_f32 v97, v97
    v_rcp_f32 v98, v98
    v_rcp_f32 v99, v99
    v_rcp_f32 v100, v100
    v_rcp_f32 v101, v101
    v_rcp_f32 v102, v102
    v_rcp_f32 v103, v103
    v_pk_fma_f32 v[40:41], v[96:97], v[40:41], v[40:41] neg_lo:[1,0,0] neg_hi:[1,0,0]
    v_pk_fma_f32 v[42:43], v[98:99], v[42:43], v[42:43] neg_lo:[1,0,0] neg_hi:[1,0,0]
    v_pk_fma_f32 v[44:45], v[100:101], v[44:45], v[44:45] neg_lo:[1,0,0] neg_hi:[1,0,0]
    v_pk_fma_f32 v[46:47], v[102:103], v[46:47], v[46:47] neg_lo:[1,0,0] neg_hi:[1,0,0]
    v_cvt_pk_bf16_f32 v76, v40, v41
    v_cvt_pk_bf16_f32 v77, v42, v43
    v_cvt_pk_bf16_f32 v78, v44, v45
    v_cvt_pk_bf16_f32 v79, v46, v47
    buffer_store_dwordx4 v[72:75], v2, s[40:43], s77 offen offset:0 sc1
    buffer_store_dwordx4 v[76:79], v2, s[40:43], s77 offen offset:1024 sc1
    s_add_u32 s77, s77, 114688
    buffer_load_dwordx4 a[80:83], v6, s[40:43], s18 offen offset:0 sc1
    buffer_load_dwordx4 a[84:87], v6, s[40:43], s18 offen offset:1024 sc1
    buffer_load_dwordx4 a[88:91], v6, s[40:43], s19 offen offset:0 sc1
    buffer_load_dwordx4 a[92:95], v6, s[40:43], s19 offen offset:1024 sc1
    buffer_load_dwordx4 a[96:99], v6, s[40:43], s20 offen offset:0 sc1
    buffer_load_dwordx4 a[100:103], v6, s[40:43], s20 offen offset:1024 sc1
    s_branch L_p5
L_idle:
    s_mov_b32 s6, s81
    s_add_u32 s81, s81, 32768
    s_cmp_eq_u32 s81, 229376
    s_cmov_b32 s81, 0
    s_mov_b32 s7, s81
    s_add_u32 s81, s81, 32768
    s_cmp_eq_u32 s81, 229376
    s_cmov_b32 s81, 0
    s_mov_b32 s8, s81
    s_add_u32 s81, s81, 32768
    s_cmp_eq_u32 s81, 229376
    s_cmov_b32 s81, 0
    s_mov_b32 s9, s81
    s_add_u32 s81, s81, 32768
    s_cmp_eq_u32 s81, 229376
    s_cmov_b32 s81, 0
    s_mov_b32 s10, s81
    s_add_u32 s81, s81, 32768
    s_cmp_eq_u32 s81, 229376
    s_cmov_b32 s81, 0
    s_mov_b32 s14, s82
    s_add_u32 s82, s82, 2048
    s_cmp_eq_u32 s82, 14336
    s_cmov_b32 s82, 0
    s_mov_b32 s15, s82
    s_add_u32 s82, s82, 2048
    s_cmp_eq_u32 s82, 14336
    s_cmov_b32 s82, 0
    s_mov_b32 s16, s82
    s_add_u32 s82, s82, 2048
    s_cmp_eq_u32 s82, 14336
    s_cmov_b32 s82, 0
    s_mov_b32 s17, s82
    s_add_u32 s82, s82, 2048
    s_cmp_eq_u32 s82, 14336
    s_cmov_b32 s82, 0
    s_mov_b32 s18, s82
    s_add_u32 s82, s82, 2048
    s_cmp_eq_u32 s82, 14336
    s_cmov_b32 s82, 0
    s_mov_b32 s19, s82
    s_add_u32 s82, s82, 2048
    s_cmp_eq_u32 s82, 14336
    s_cmov_b32 s82, 0
    s_mov_b32 s20, s82
    s_add_u32 s82, s82, 2048
    s_cmp_eq_u32 s82, 14336
    s_cmov_b32 s82, 0
    s_waitcnt vmcnt(0)
    s_barrier
    s_add_u32 m0, s86, 0
    s_nop 0
    buffer_load_dwordx4 v12, s[28:31], s6 offen offset:0 lds
    buffer_load_dwordx4 v13, s[28:31], s6 offen offset:1024 lds
    buffer_load_dwordx4 v14, s[28:31], s6 offen offset:2048 lds
    buffer_load_dwordx4 v15, s[28:31], s6 offen offset:3072 lds
    s_add_u32 m0, s86, 4096
    s_nop 0
    buffer_load_dwordx4 v12, s[28:31], s7 offen offset:0 lds
    buffer_load_dwordx4 v13, s[28:31], s7 offen offset:1024 lds
    buffer_load_dwordx4 v14, s[28:31], s7 offen offset:2048 lds
    buffer_load_dwordx4 v15, s[28:31], s7 offen offset:3072 lds
    s_add_u32 m0, s86, 32768
    s_nop 0
    buffer_load_dwordx4 v12, s[28:31], s8 offen offset:0 lds
    buffer_load_dwordx4 v13, s[28:31], s8 offen offset:1024 lds
    buffer_load_dwordx4 v14, s[28:31], s8 offen offset:2048 lds
    buffer_load_dwordx4 v15, s[28:31], s8 offen offset:3072 lds
    s_add_u32 m0, s86, 36864
    s_nop 0
    buffer_load_dwordx4 v12, s[28:31], s9 offen offset:0 lds
    buffer_load_dwordx4 v13, s[28:31], s9 offen offset:1024 lds
    buffer_load_dwordx4 v14, s[28:31], s9 offen offset:2048 lds
    buffer_load_dwordx4 v15, s[28:31], s9 offen offset:3072 lds
    s_add_u32 m0, s86, 65536
    s_nop 0
    buffer_load_dwordx4 v12, s[28:31], s10 offen offset:0 lds
    buffer_load_dwordx4 v13, s[28:31], s10 offen offset:1024 lds
    buffer_load_dwordx4 v14, s[28:31], s10 offen offset:2048 lds
    buffer_load_dwordx4 v15, s[28:31], s10 offen offset:3072 lds
    s_cmp_lg_u32 s46, 3
    s_cbranch_scc1 L_nopoll_21
    s_add_u32 s88, s67, 98304
    s_mov_b64 exec, 0x3fff
L_poll_22:
    buffer_load_dword v31, v3, s[40:43], s88 offen sc1
    s_add_u32 s59, s59, 1
    s_cmp_gt_u32 s59, 400000
    s_cbranch_scc1 L_poll_22_y
    s_waitcnt vmcnt(0)
    v_cmp_ne_u32 vcc, s36, v31
    s_nop 0
    s_cbranch_vccnz L_poll_22
L_poll_22_y:
    s_waitcnt vmcnt(0)
    s_mov_b64 exec, -1
L_nopoll_21:
    s_barrier
    buffer_load_dwordx4 a[48:51], v6, s[40:43], s14 offen offset:0 sc1
    buffer_load_dwordx4 a[52:55], v6, s[40:43], s14 offen offset:1024 sc1
    buffer_load_dwordx4 a[56:59], v6, s[40:43], s15 offen offset:0 sc1
    buffer_load_dwordx4 a[60:63], v6, s[40:43], s15 offen offset:1024 sc1
    buffer_load_dwordx4 a[64:67], v6, s[40:43], s16 offen offset:0 sc1
    buffer_load_dwordx4 a[68:71], v6, s[40:43], s16 offen offset:1024 sc1
    buffer_load_dwordx4 a[72:75], v6, s[40:43], s17 offen offset:0 sc1
    buffer_load_dwordx4 a[76:79], v6, s[40:43], s17 offen offset:1024 sc1
    buffer_load_dwordx4 a[80:83], v6, s[40:43], s18 offen offset:0 sc1
    buffer_load_dwordx4 a[84:87], v6, s[40:43], s18 offen offset:1024 sc1
    buffer_load_dwordx4 a[88:91], v6, s[40:43], s19 offen offset:0 sc1
    buffer_load_dwordx4 a[92:95], v6, s[40:43], s19 offen offset:1024 sc1
    buffer_load_dwordx4 a[96:99], v6, s[40:43], s20 offen offset:0 sc1
    buffer_load_dwordx4 a[100:103], v6, s[40:43], s20 offen offset:1024 sc1
    s_mov_b64 exec, 1
    buffer_load_dword v11, v3, s[40:43], s67 offen sc1
    buffer_load_dword v11, v3, s[40:43], s67 offen sc1
    buffer_load_dword v11, v3, s[40:43], s67 offen sc1
    buffer_load_dword v11, v3, s[40:43], s67 offen sc1
    s_mov_b64 exec, -1
L_p5:
    ds_read_b64_tr_b16 a[112:113], v116 offset:0
    ds_read_b64_tr_b16 a[114:115], v116 offset:256
    ds_read_b64_tr_b16 a[116:117], v117 offset:0
    ds_read_b64_tr_b16 a[118:119], v117 offset:256
    ds_read_b64_tr_b16 a[120:121], v116 offset:1024
    ds_read_b64_tr_b16 a[122:123], v116 offset:1280
    ds_read_b64_tr_b16 a[124:125], v117 offset:1024
    ds_read_b64_tr_b16 a[126:127], v117 offset:1280
    ds_read_b64_tr_b16 a[128:129], v116 offset:4096
    ds_read_b64_tr_b16 a[130:131], v116 offset:4352
    ds_read_b64_tr_b16 a[132:133], v117 offset:4096
    ds_read_b64_tr_b16 a[134:135], v117 offset:4352
    s_waitcnt vmcnt(17) lgkmcnt(10)
    v_mfma_f32_32x32x16_bf16 v[192:207], a[112:115], a[48:51], 0
    ds_read_b64_tr_b16 a[136:137], v116 offset:5120
    ds_read_b64_tr_b16 a[138:139], v116 offset:5376
    v_lshlrev_b32 v96, 16, v20
    v_and_b32 v97, 0xffff0000, v20
    s_waitcnt lgkmcnt(10)
    v_mfma_f32_32x32x16_bf16 v[208:223], a[116:119], a[48:51], 0
    ds_read_b64_tr_b16 a[140:141], v117 offset:5120
    ds_read_b64_tr_b16 a[142:143], v117 offset:5376
    v_lshlrev_b32 v98, 16, v21
    s_waitcnt vmcnt(16) lgkmcnt(10)
    v_mfma_f32_32x32x16_bf16 v[192:207], a[120:123], a[52:55], v[192:207]
    ds_read_b64_tr_b16 a[144:145], v114 offset:0
    ds_read_b64_tr_b16 a[146:147], v114 offset:256
    v_and_b32 v99, 0xffff0000, v21
    v_lshlrev_b32 v100, 16, v22
    s_waitcnt lgkmcnt(10)
    v_mfma_f32_32x32x16_bf16 v[208:223], a[124:127], a[52:55], v[208:223]
    ds_read_b64_tr_b16 a[148:149], v115 offset:0
    ds_read_b64_tr_b16 a[150:151], v115 offset:256
    v_and_b32 v101, 0xffff0000, v22
    s_waitcnt vmcnt(15) lgkmcnt(10)
    v_mfma_f32_32x32x16_bf16 v[192:207], a[128:131], a[56:59], v[192:207]
    ds_read_b64_tr_b16 a[152:153], v114 offset:1024
    ds_read_b64_tr_b16 a[154:155], v114 offset:1280
    v_lshlrev_b32 v102, 16, v23
    v_and_b32 v103, 0xffff0000, v23
    s_waitcnt lgkmcnt(10)
    v_mfma_f32_32x32x16_bf16 v[208:223], a[132:135], a[56:59], v[208:223]
    ds_read_b64_tr_b16 a[156:157], v115 offset:1024
    ds_read_b64_tr_b16 a[158:159], v115 offset:1280
    v_lshlrev_b32 v104, 16, v24
    s_waitcnt vmcnt(14) lgkmcnt(10)
    v_mfma_f32_32x32x16_bf16 v[192:207], a[136:139], a[60:63], v[192:207]
    ds_read_b64_tr_b16 a[160:161], v114 offset:4096
    ds_read_b64_tr_b16 a[162:163], v114 offset:4352
    v_and_b32 v105, 0xffff0000, v24
    v_lshlrev_b32 v106, 16, v25
    s_waitcnt lgkmcnt(10)
    v_mfma_f32_32x32x16_bf16 v[208:223], a[140:143], a[60:63], v[208:223]
    ds_read_b64_tr_b16 a[164:165], v115 offset:4096
    ds_read_b64_tr_b16 a[166:167], v115 offset:4352
    v_and_b32 v107, 0xffff0000, v25
    s_waitcnt vmcnt(13) lgkmcnt(10)
    v_mfma_f32_32x32x16_bf16 v[192:207], a[144:147], a[64:67], v[192:207]
    ds_read_b64_tr_b16 a[168:169], v114 offset:5120
    ds_read_b64_tr_b16 a[170:171], v114 offset:5376
    v_lshlrev_b32 v108, 16, v26
    v_and_b32 v109, 0xffff0000, v26
    s_waitcnt lgkmcnt(10)
    v_mfma_f32_32x32x16_bf16 v[208:223], a[148:151], a[64:67], v[208:223]
    ds_read_b64_tr_b16 a[172:173], v115 offset:5120
    ds_read_b64_tr_b16 a[174:175], v115 offset:5376
    v_lshlrev_b32 v110, 16, v27
    s_waitcnt vmcnt(12) lgkmcnt(10)
    v_mfma_f32_32x32x16_bf16 v[192:207], a[152:155], a[68:71], v[192:207]
    ds_read_b64_tr_b16 a[176:177], v114 offset:32768
    ds_read_b64_tr_b16 a[178:179], v114 offset:33024
    v_and_b32 v111, 0xffff0000, v27
    s_waitcnt lgkmcnt(10)
    v_mfma_f32_32x32x16_bf16 v[208:223], a[156:159], a[68:71], v[208:223]
    ds_read_b64_tr_b16 a[180:181], v115 offset:32768
    ds_read_b64_tr_b16 a[182:183], v115 offset:33024
    s_waitcnt vmcnt(11) lgkmcnt(10)
    v_mfma_f32_32x32x16_bf16 v[192:207], a[160:163], a[72:75], v[192:207]
    ds_read_b64_tr_b16 a[184:185], v114 offset:33792
    ds_read_b64_tr_b16 a[186:187], v114 offset:34048
    v_accvgpr_read_b32 v16, a250
    v_accvgpr_read_b32 v12, a252
    s_waitcnt lgkmcnt(10)
    v_mfma_f32_32x32x16_bf16 v[208:223], a[164:167], a[72:75], v[208:223]
    ds_read_b64_tr_b16 a[188:189], v115 offset:33792
    ds_read_b64_tr_b16 a[190:191], v115 offset:34048
    v_accvgpr_read_b32 v13, a251
    s_cmp_lg_u32 s46, 3
    s_cbranch_scc1 L_noci_23
    s_add_u32 s88, s67, 98432
    s_mov_b64 exec, 0xffff
    buffer_load_dword v113, v3, s[40:43], s88 offen sc1
    s_mov_b64 exec, -1
L_noci_23:
    s_waitcnt vmcnt(6)
    s_barrier
    s_cmp_ge_u32 s45, 14
    s_cbranch_scc1 L_noe_24
    s_cmp_lg_u32 s46, 0
    s_cbranch_scc1 L_noarr_25
    s_add_u32 s88, s85, 98560
    s_mov_b64 exec, 1
    s_cmp_lg_u32 s60, 0
    s_cbranch_scc1 L_noarr_25_l
    buffer_store_dword v121, v3, s[40:43], s88 offen sc1
    s_branch L_noarr_25_e
L_noarr_25_l:
    buffer_store_dword v121, v3, s[40:43], s88 offen
L_noarr_25_e:
    s_mov_b64 exec, -1
L_noarr_25:
L_noe_24:
    s_waitcnt lgkmcnt(10)
    v_mfma_f32_32x32x16_bf16 v[192:207], a[168:171], a[76:79], v[192:207]
    ds_read_b64_tr_b16 a[192:193], v114 offset:36864
    ds_read_b64_tr_b16 a[194:195], v114 offset:37120
    v_xor_b32 v17, 32, v16
    v_xor_b32 v18, 4224, v16
    s_waitcnt lgkmcnt(10)
    v_mfma_f32_32x32x16_bf16 v[208:223], a[172:175], a[76:79], v[208:223]
    ds_read_b64_tr_b16 a[196:197], v115 offset:36864
    ds_read_b64_tr_b16 a[198:199], v115 offset:37120
    v_xor_b32 v19, 4256, v16
    s_waitcnt vmcnt(5) lgkmcnt(10)
    v_mfma_f32_32x32x16_bf16 v[192:207], a[176:179], a[80:83], v[192:207]
    ds_read_b64_tr_b16 a[200:201], v114 offset:37888
    ds_read_b64_tr_b16 a[202:203], v114 offset:38144
    v_mul_f32 v224, s80, v96
    v_mul_f32 v225, s80, v97
    s_waitcnt lgkmcnt(10)
    v_mfma_f32_32x32x16_bf16 v[208:223], a[180:183], a[80:83], v[208:223]
    ds_read_b64_tr_b16 a[204:205], v115 offset:37888
    ds_read_b64_tr_b16 a[206:207], v115 offset:38144
    v_mul_f32 v226, s80, v98
    s_cmp_lg_u32 s46, 3
    s_cbranch_scc1 L_chk_26_z
    s_mov_b64 exec, 0x3fff
    s_waitcnt vmcnt(0)
    v_cmp_ne_u32 vcc, s36, v113
    s_nop 0
    s_cbranch_vccz L_chk_26_x
    s_add_u32 s88, s67, 98432
L_chk_26:
    buffer_load_dword v113, v3, s[40:43], s88 offen sc1
    s_add_u32 s59, s59, 1
    s_cmp_gt_u32 s59, 400000
    s_cbranch_scc1 L_chk_26_y
    s_waitcnt vmcnt(0)
    v_cmp_ne_u32 vcc, s36, v113
    s_nop 0
    s_cbranch_vccnz L_chk_26
L_chk_26_y:
    s_waitcnt vmcnt(0)
L_chk_26_x:
    s_mov_b64 exec, -1
L_chk_26_z:
    s_barrier
    s_waitcnt vmcnt(4) lgkmcnt(10)
    v_mfma_f32_32x32x16_bf16 v[192:207], a[184:187], a[84:87], v[192:207]
    ds_read_b64_tr_b16 a[208:209], v126 offset:0
    ds_read_b64_tr_b16 a[210:211], v126 offset:256
    buffer_load_dwordx4 v[128:131], v7, s[40:43], s14 offen offset:0 sc1
    buffer_load_dwordx4 v[132:135], v7, s[40:43], s14 offen offset:1024 sc1
    v_mul_f32 v227, s80, v99
    s_waitcnt lgkmcnt(10)
    v_mfma_f32_32x32x16_bf16 v[208:223], a[188:191], a[84:87], v[208:223]
    ds_read_b64_tr_b16 a[212:213], v127 offset:0
    ds_read_b64_tr_b16 a[214:215], v127 offset:256
    v_mul_f32 v228, s80, v100
    v_mul_f32 v229, s80, v101
    s_waitcnt vmcnt(5) lgkmcnt(10)
    v_mfma_f32_32x32x16_bf16 v[192:207], a[192:195], a[88:91], v[192:207]
    ds_read_b64_tr_b16 a[216:217], v126 offset:1024
    ds_read_b64_tr_b16 a[218:219], v126 offset:1280
    buffer_load_dwordx4 v[136:139], v7, s[40:43], s15 offen offset:0 sc1
    buffer_load_dwordx4 v[140:143], v7, s[40:43], s15 offen offset:1024 sc1
    v_mul_f32 v230, s80, v102
    s_waitcnt lgkmcnt(10)
    v_mfma_f32_32x32x16_bf16 v[208:223], a[196:199], a[88:91], v[208:223]
    ds_read_b64_tr_b16 a[220:221], v127 offset:1024
    ds_read_b64_tr_b16 a[222:223], v127 offset:1280
    v_mul_f32 v231, s80, v103
    v_mul_f32 v232, s80, v104
    s_waitcnt vmcnt(6) lgkmcnt(10)
    v_mfma_f32_32x32x16_bf16 v[192:207], a[200:203], a[92:95], v[192:207]
    buffer_load_dwordx4 v[144:147], v7, s[40:43], s16 offen offset:0 sc1
    buffer_load_dwordx4 v[148:151], v7, s[40:43], s16 offen offset:1024 sc1
    v_mul_f32 v233, s80, v105
    s_waitcnt lgkmcnt(8)
    v_mfma_f32_32x32x16_bf16 v[208:223], a[204:207], a[92:95], v[208:223]
    v_mul_f32 v234, s80, v106
    v_mul_f32 v235, s80, v107
    s_cmp_lg_u32 s46, 3
    s_cbranch_scc1 L_noci_27
    s_add_u32 s88, s67, 98560
    s_mov_b64 exec, 0xffff
    buffer_load_dword v113, v3, s[40:43], s88 offen sc1
    s_mov_b64 exec, -1
L_noci_27:
    s_waitcnt vmcnt(7) lgkmcnt(6)
    v_mfma_f32_32x32x16_bf16 v[192:207], a[208:211], a[96:99], v[192:207]
    buffer_load_dwordx4 v[152:155], v7, s[40:43], s17 offen offset:0 sc1
    buffer_load_dwordx4 v[156:159], v7, s[40:43], s17 offen offset:1024 sc1
    v_mul_f32 v236, s80, v108
    s_waitcnt lgkmcnt(4)
    v_mfma_f32_32x32x16_bf16 v[208:223], a[212:215], a[96:99], v[208:223]
    v_mul_f32 v237, s80, v109
    v_mul_f32 v238, s80, v110
    s_waitcnt vmcnt(8) lgkmcnt(2)
    v_mfma_f32_32x32x16_bf16 v[192:207], a[216:219], a[100:103], v[192:207]
    buffer_load_dwordx4 v[160:163], v7, s[40:43], s18 offen offset:0 sc1
    buffer_load_dwordx4 v[164:167], v7, s[40:43], s18 offen offset:1024 sc1
    s_waitcnt lgkmcnt(0)
    v_mfma_f32_32x32x16_bf16 v[208:223], a[220:223], a[100:103], v[208:223]
    v_mul_f32 v239, s80, v111
    s_waitcnt vmcnt(9)
    s_nop 0
    v_mfma_f32_32x32x16_bf16 v[224:239], a[112:115], v[128:131], v[224:239]
    buffer_load_dwordx4 v[168:171], v7, s[40:43], s19 offen offset:0 sc1
    v_mfma_f32_32x32x16_bf16 v[240:255], a[116:119], v[128:131], 0
    buffer_load_dwordx4 v[172:175], v7, s[40:43], s19 offen offset:1024 sc1
    s_waitcnt vmcnt(10)
    v_mfma_f32_32x32x16_bf16 v[224:239], a[120:123], v[132:135], v[224:239]
    buffer_load_dwordx4 v[176:179], v7, s[40:43], s20 offen offset:0 sc1
    buffer_load_dwordx4 v[180:183], v7, s[40:43], s20 offen offset:1024 sc1
    s_nop 0
    ds_write_b128 v18, v[208:211] offset:0
    ds_write_b128 v18, v[212:215] offset:1024
    v_fma_f32 v192, v96, s79, v192
    v_fma_f32 v193, v97, s79, v193
    v_mfma_f32_32x32x16_bf16 v[240:255], a[124:127], v[132:135], v[240:255]
    v_fma_f32 v194, v98, s79, v194
    v_fma_f32 v195, v99, s79, v195
    v_fma_f32 v196, v100, s79, v196
    v_fma_f32 v197, v101, s79, v197
    v_fma_f32 v198, v102, s79, v198
    v_fma_f32 v199, v103, s79, v199
    s_cmp_lg_u32 s46, 3
    s_cbranch_scc1 L_chk_28_z
    s_mov_b64 exec, 0x3fff
    s_waitcnt vmcnt(8)
    v_cmp_ne_u32 vcc, s36, v113
    s_nop 0
    s_cbranch_vccz L_chk_28_x
    s_add_u32 s88, s67, 98560
L_chk_28:
    buffer_load_dword v113, v3, s[40:43], s88 offen sc1
    s_add_u32 s59, s59, 1
    s_cmp_gt_u32 s59, 400000
    s_cbranch_scc1 L_chk_28_y
    s_waitcnt vmcnt(0)
    v_cmp_ne_u32 vcc, s36, v113
    s_nop 0
    s_cbranch_vccnz L_chk_28
L_chk_28_y:
    s_waitcnt vmcnt(0)
L_chk_28_x:
    s_mov_b64 exec, -1
L_chk_28_z:
    s_barrier
    s_waitcnt vmcnt(11)
    v_mfma_f32_32x32x16_bf16 v[224:239], a[128:131], v[136:139], v[224:239]
    buffer_load_dwordx4 v[184:187], v8, s[40:43], s14 offen offset:0 sc1
    ds_write_b128 v19, v[216:219] offset:2048
    ds_write_b128 v19, v[220:223] offset:3072
    v_fma_f32 v200, v104, s79, v200
    v_fma_f32 v201, v105, s79, v201
    v_fma_f32 v202, v106, s79, v202
    v_mfma_f32_32x32x16_bf16 v[240:255], a[132:135], v[136:139], v[240:255]
    v_fma_f32 v203, v107, s79, v203
    v_fma_f32 v204, v108, s79, v204
    v_fma_f32 v205, v109, s79, v205
    v_fma_f32 v206, v110, s79, v206
    v_fma_f32 v207, v111, s79, v207
    s_waitcnt vmcnt(11)
    v_mfma_f32_32x32x16_bf16 v[224:239], a[136:139], v[140:143], v[224:239]
    buffer_load_dwordx4 v[188:191], v8, s[40:43], s14 offen offset:1024 sc1
    ds_write_b128 v16, v[192:195] offset:0
    v_mfma_f32_32x32x16_bf16 v[240:255], a[140:143], v[140:143], v[240:255]
    ds_write_b128 v16, v[196:199] offset:1024
    s_waitcnt vmcnt(11)
    v_mfma_f32_32x32x16_bf16 v[224:239], a[144:147], v[144:147], v[224:239]
    buffer_load_dwordx4 v[128:131], v8, s[40:43], s15 offen offset:0 sc1
    ds_write_b128 v17, v[200:203] offset:2048
    v_mfma_f32_32x32x16_bf16 v[240:255], a[148:151], v[144:147], v[240:255]
    ds_write_b128 v17, v[204:207] offset:3072
    s_waitcnt vmcnt(11)
    v_mfma_f32_32x32x16_bf16 v[224:239], a[152:155], v[148:151], v[224:239]
    buffer_load_dwordx4 v[132:135], v8, s[40:43], s15 offen offset:1024 sc1
    v_mfma_f32_32x32x16_bf16 v[240:255], a[156:159], v[148:151], v[240:255]
    s_waitcnt lgkmcnt(0)
    s_barrier
    s_waitcnt vmcnt(11)
    v_mfma_f32_32x32x16_bf16 v[224:239], a[160:163], v[152:155], v[224:239]
    buffer_load_dwordx4 v[136:139], v8, s[40:43], s16 offen offset:0 sc1
    ds_read_b128 v[32:35], v12 offset:0
    ds_read_b128 v[36:39], v12 offset:1024
    v_mfma_f32_32x32x16_bf16 v[240:255], a[164:167], v[152:155], v[240:255]
    ds_read_b128 v[40:43], v12 offset:8192
    ds_read_b128 v[44:47], v12 offset:9216
    s_waitcnt vmcnt(11)
    v_mfma_f32_32x32x16_bf16 v[224:239], a[168:171], v[156:159], v[224:239]
    buffer_load_dwordx4 v[140:143], v8, s[40:43], s16 offen offset:1024 sc1
    ds_read_b128 v[48:51], v12 offset:16384
    ds_read_b128 v[52:55], v12 offset:17408
    v_mfma_f32_32x32x16_bf16 v[240:255], a[172:175], v[156:159], v[240:255]
    ds_read_b128 v[56:59], v12 offset:24576
    ds_read_b128 v[60:63], v12 offset:25600
    s_waitcnt vmcnt(11)
    v_mfma_f32_32x32x16_bf16 v[224:239], a[176:179], v[160:163], v[224:239]
    buffer_load_dwordx4 v[144:147], v8, s[40:43], s17 offen offset:0 sc1
    s_waitcnt lgkmcnt(5)
    v_add_f32 v32, v32, v40
    v_add_f32 v33, v33, v41
    v_mfma_f32_32x32x16_bf16 v[240:255], a[180:183], v[160:163], v[240:255]
    v_add_f32 v34, v34, v42
    v_add_f32 v35, v35, v43
    s_waitcnt lgkmcnt(4)
    v_add_f32 v36, v36, v44
    s_waitcnt vmcnt(11)
    v_mfma_f32_32x32x16_bf16 v[224:239], a[184:187], v[164:167], v[224:239]
    buffer_load_dwordx4 v[148:151], v8, s[40:43], s17 offen offset:1024 sc1
    v_add_f32 v37, v37, v45
    v_add_f32 v38, v38, v46
    v_mfma_f32_32x32x16_bf16 v[240:255], a[188:191], v[164:167], v[240:255]
    v_add_f32 v39, v39, v47
    s_waitcnt lgkmcnt(1)
    v_add_f32 v48, v48, v56
    v_add_f32 v49, v49, v57
    s_waitcnt vmcnt(11)
    v_mfma_f32_32x32x16_bf16 v[224:239], a[192:195], v[168:171], v[224:239]
    buffer_load_dwordx4 v[152:155], v8, s[40:43], s18 offen offset:0 sc1
    v_add_f32 v50, v50, v58
    v_add_f32 v51, v51, v59
    v_mfma_f32_32x32x16_bf16 v[240:255], a[196:199], v[168:171], v[240:255]
    s_waitcnt lgkmcnt(0)
    v_add_f32 v52, v52, v60
    v_add_f32 v53, v53, v61
    v_add_f32 v54, v54, v62
    s_waitcnt vmcnt(11)
    v_mfma_f32_32x32x16_bf16 v[224:239], a[200:203], v[172:175], v[224:239]
    buffer_load_dwordx4 v[156:159], v8, s[40:43], s18 offen offset:1024 sc1
    v_add_f32 v55, v55, v63
    v_add_f32 v32, v32, v48
    v_mfma_f32_32x32x16_bf16 v[240:255], a[204:207], v[172:175], v[240:255]
    v_add_f32 v33, v33, v49
    v_add_f32 v34, v34, v50
    v_add_f32 v35, v35, v51
    s_waitcnt vmcnt(11)
    v_mfma_f32_32x32x16_bf16 v[224:239], a[208:211], v[176:179], v[224:239]
    buffer_load_dwordx4 v[160:163], v8, s[40:43], s19 offen offset:0 sc1
    v_add_f32 v36, v36, v52
    v_add_f32 v37, v37, v53
    v_mfma_f32_32x32x16_bf16 v[240:255], a[212:215], v[176:179], v[240:255]
    v_add_f32 v38, v38, v54
    v_add_f32 v39, v39, v55
    s_waitcnt vmcnt(11)
    v_mfma_f32_32x32x16_bf16 v[224:239], a[216:219], v[180:183], v[224:239]
    buffer_load_dwordx4 v[164:167], v8, s[40:43], s19 offen offset:1024 sc1
    v_mfma_f32_32x32x16_bf16 v[240:255], a[220:223], v[180:183], v[240:255]
    s_cmp_eq_u32 s61, 0
    s_cbranch_scc1 L_rt_29_k
    v_cvt_pk_bf16_f32 v72, v32, v33
    v_cvt_pk_bf16_f32 v73, v34, v35
    v_cvt_pk_bf16_f32 v74, v36, v37
    v_cvt_pk_bf16_f32 v75, v38, v39
    s_branch L_rt_29_e
L_rt_29_k:
    v_mov_b32 v64, v32
    v_mov_b32 v65, v33
    v_mov_b32 v66, v34
    v_mov_b32 v67, v35
    v_mov_b32 v68, v36
    v_mov_b32 v69, v37
    v_mov_b32 v70, v38
    v_mov_b32 v71, v39
L_rt_29_e:
    s_waitcnt vmcnt(11)
    v_mfma_f32_32x32x16_bf16 v[192:207], a[112:115], v[184:187], 0
    buffer_load_dwordx4 v[168:171], v8, s[40:43], s20 offen offset:0 sc1
    v_mfma_f32_32x32x16_bf16 v[208:223], a[116:119], v[184:187], 0
    s_waitcnt vmcnt(11)
    v_mfma_f32_32x32x16_bf16 v[192:207], a[120:123], v[188:191], v[192:207]
    buffer_load_dwordx4 v[172:175], v8, s[40:43], s20 offen offset:1024 sc1
    ds_write_b128 v18, v[240:243] offset:32768
    v_mfma_f32_32x32x16_bf16 v[208:223], a[124:127], v[188:191], v[208:223]
    ds_write_b128 v18, v[244:247] offset:33792
    s_waitcnt vmcnt(11)
    v_mfma_f32_32x32x16_bf16 v[192:207], a[128:131], v[128:131], v[192:207]
    buffer_load_dwordx4 v[176:179], v9, s[40:43], s14 offen offset:0 sc1
    ds_write_b128 v19, v[248:251] offset:34816
    ds_write_b128 v19, v[252:255] offset:35840
    v_mfma_f32_32x32x16_bf16 v[208:223], a[132:135], v[128:131], v[208:223]
    s_mov_b64 exec, 0xffff
    buffer_load_dword v11, v10, s[40:43], s64 offen sc1
    s_mov_b64 exec, -1
    s_waitcnt vmcnt(12)
    v_mfma_f32_32x32x16_bf16 v[192:207], a[136:139], v[132:135], v[192:207]
    buffer_load_dwordx4 v[180:183], v9, s[40:43], s14 offen offset:1024 sc1
    ds_write_b128 v16, v[224:227] offset:32768
    v_mfma_f32_32x32x16_bf16 v[208:223], a[140:143], v[132:135], v[208:223]
    ds_write_b128 v16, v[228:231] offset:33792
    s_waitcnt vmcnt(12)
    v_mfma_f32_32x32x16_bf16 v[192:207], a[144:147], v[136:139], v[192:207]
    buffer_load_dwordx4 v[184:187], v9, s[40:43], s15 offen offset:0 sc1
    ds_write_b128 v17, v[232:235] offset:34816
    v_mfma_f32_32x32x16_bf16 v[208:223], a[148:151], v[136:139], v[208:223]
    ds_write_b128 v17, v[236:239] offset:35840
    s_waitcnt vmcnt(12)
    v_mfma_f32_32x32x16_bf16 v[192:207], a[152:155], v[140:143], v[192:207]
    buffer_load_dwordx4 v[188:191], v9, s[40:43], s15 offen offset:1024 sc1
    v_mfma_f32_32x32x16_bf16 v[208:223], a[156:159], v[140:143], v[208:223]
    s_waitcnt lgkmcnt(0)
    s_barrier
    s_waitcnt vmcnt(12)
    v_mfma_f32_32x32x16_bf16 v[192:207], a[160:163], v[144:147], v[192:207]
    buffer_load_dwordx4 v[128:131], v9, s[40:43], s16 offen offset:0 sc1
    ds_read_b128 v[32:35], v12 offset:32768
    ds_read_b128 v[36:39], v12 offset:33792
    v_mfma_f32_32x32x16_bf16 v[208:223], a[164:167], v[144:147], v[208:223]
    ds_read_b128 v[40:43], v12 offset:40960
    ds_read_b128 v[44:47], v12 offset:41984
    s_waitcnt vmcnt(12)
    v_mfma_f32_32x32x16_bf16 v[192:207], a[168:171], v[148:151], v[192:207]
    buffer_load_dwordx4 v[132:135], v9, s[40:43], s16 offen offset:1024 sc1
    ds_read_b128 v[48:51], v12 offset:49152
    ds_read_b128 v[52:55], v12 offset:50176
    ds_read_b128 v[56:59], v12 offset:57344
    v_mfma_f32_32x32x16_bf16 v[208:223], a[172:175], v[148:151], v[208:223]
    ds_read_b128 v[60:63], v12 offset:58368
    v_mul_f32 v224, s83, v96
    v_mul_f32 v225, s83, v97
    v_mul_f32 v226, s83, v98
    s_waitcnt vmcnt(12)
    v_mfma_f32_32x32x16_bf16 v[192:207], a[176:179], v[152:155], v[192:207]
    buffer_load_dwordx4 v[136:139], v9, s[40:43], s17 offen offset:0 sc1
    s_waitcnt lgkmcnt(5)
    v_add_f32 v32, v32, v40
    v_add_f32 v33, v33, v41
    v_add_f32 v34, v34, v42
    v_add_f32 v35, v35, v43
    v_mfma_f32_32x32x16_bf16 v[208:223], a[180:183], v[152:155], v[208:223]
    s_waitcnt lgkmcnt(4)
    v_add_f32 v36, v36, v44
    v_mul_f32 v227, s83, v99
    v_mul_f32 v228, s83, v100
    v_mul_f32 v229, s83, v101
    s_waitcnt vmcnt(12)
    v_mfma_f32_32x32x16_bf16 v[192:207], a[184:187], v[156:159], v[192:207]
    buffer_load_dwordx4 v[140:143], v9, s[40:43], s17 offen offset:1024 sc1
    v_add_f32 v37, v37, v45
    v_add_f32 v38, v38, v46
    v_add_f32 v39, v39, v47
    s_waitcnt lgkmcnt(1)
    v_add_f32 v48, v48, v56
    v_mfma_f32_32x32x16_bf16 v[208:223], a[188:191], v[156:159], v[208:223]
    v_add_f32 v49, v49, v57
    v_mul_f32 v230, s83, v102
    v_mul_f32 v231, s83, v103
    v_mul_f32 v232, s83, v104
    s_waitcnt vmcnt(12)
    v_mfma_f32_32x32x16_bf16 v[192:207], a[192:195], v[160:163], v[192:207]
    buffer_load_dwordx4 v[144:147], v9, s[40:43], s18 offen offset:0 sc1
    v_add_f32 v50, v50, v58
    v_add_f32 v51, v51, v59
    s_waitcnt lgkmcnt(0)
    v_add_f32 v52, v52, v60
    v_add_f32 v53, v53, v61
    v_mfma_f32_32x32x16_bf16 v[208:223], a[196:199], v[160:163], v[208:223]
    v_add_f32 v54, v54, v62
    v_mul_f32 v233, s83, v105
    v_mul_f32 v234, s83, v106
    v_mul_f32 v235, s83, v107
    s_waitcnt vmcnt(12)
    v_mfma_f32_32x32x16_bf16 v[192:207], a[200:203], v[164:167], v[192:207]
    buffer_load_dwordx4 v[148:151], v9, s[40:43], s18 offen offset:1024 sc1
    v_add_f32 v55, v55, v63
    v_add_f32 v32, v32, v48
    v_add_f32 v33, v33, v49
    v_add_f32 v34, v34, v50
    v_mfma_f32_32x32x16_bf16 v[208:223], a[204:207], v[164:167], v[208:223]
    v_add_f32 v35, v35, v51
    v_mul_f32 v236, s83, v108
    v_mul_f32 v237, s83, v109
    v_mul_f32 v238, s83, v110
    s_waitcnt vmcnt(12)
    v_mfma_f32_32x32x16_bf16 v[192:207], a[208:211], v[168:171], v[192:207]
    buffer_load_dwordx4 v[152:155], v9, s[40:43], s19 offen offset:0 sc1
    v_add_f32 v36, v36, v52
    v_add_f32 v37, v37, v53
    v_mfma_f32_32x32x16_bf16 v[208:223], a[212:215], v[168:171], v[208:223]
    v_add_f32 v38, v38, v54
    v_add_f32 v39, v39, v55
    v_mul_f32 v239, s83, v111
    s_waitcnt vmcnt(12)
    v_mfma_f32_32x32x16_bf16 v[192:207], a[216:219], v[172:175], v[192:207]
    buffer_load_dwordx4 v[156:159], v9, s[40:43], s19 offen offset:1024 sc1
    v_mfma_f32_32x32x16_bf16 v[208:223], a[220:223], v[172:175], v[208:223]
    s_cmp_eq_u32 s61, 1
    s_cbranch_scc1 L_rt_30_k
    v_cvt_pk_bf16_f32 v72, v32, v33
    v_cvt_pk_bf16_f32 v73, v34, v35
    v_cvt_pk_bf16_f32 v74, v36, v37
    v_cvt_pk_bf16_f32 v75, v38, v39
    s_branch L_rt_30_e
L_rt_30_k:
    v_mov_b32 v64, v32
    v_mov_b32 v65, v33
    v_mov_b32 v66, v34
    v_mov_b32 v67, v35
    v_mov_b32 v68, v36
    v_mov_b32 v69, v37
    v_mov_b32 v70, v38
    v_mov_b32 v71, v39
L_rt_30_e:
    s_waitcnt vmcnt(12)
    v_mfma_f32_32x32x16_bf16 v[224:239], a[112:115], v[176:179], v[224:239]
    buffer_load_dwordx4 v[160:163], v9, s[40:43], s20 offen offset:0 sc1
    v_mfma_f32_32x32x16_bf16 v[240:255], a[116:119], v[176:179], 0
    s_waitcnt vmcnt(11)
    v_mfma_f32_32x32x16_bf16 v[224:239], a[120:123], v[180:183], v[224:239]
    buffer_load_dwordx4 v[164:167], v9, s[40:43], s20 offen offset:1024 sc1
    ds_write_b128 v18, v[208:211] offset:0
    v_mfma_f32_32x32x16_bf16 v[240:255], a[124:127], v[180:183], v[240:255]
    ds_write_b128 v18, v[212:215] offset:1024
    s_waitcnt vmcnt(11)
    v_mfma_f32_32x32x16_bf16 v[224:239], a[128:131], v[184:187], v[224:239]
    ds_write_b128 v19, v[216:219] offset:2048
    v_mfma_f32_32x32x16_bf16 v[240:255], a[132:135], v[184:187], v[240:255]
    ds_write_b128 v19, v[220:223] offset:3072
    s_waitcnt vmcnt(10)
    v_mfma_f32_32x32x16_bf16 v[224:239], a[136:139], v[188:191], v[224:239]
    ds_write_b128 v16, v[192:195] offset:0
    v_mfma_f32_32x32x16_bf16 v[240:255], a[140:143], v[188:191], v[240:255]
    ds_write_b128 v16, v[196:199] offset:1024
    s_waitcnt vmcnt(9)
    v_mfma_f32_32x32x16_bf16 v[224:239], a[144:147], v[128:131], v[224:239]
    ds_write_b128 v17, v[200:203] offset:2048
    v_mfma_f32_32x32x16_bf16 v[240:255], a[148:151], v[128:131], v[240:255]
    ds_write_b128 v17, v[204:207] offset:3072
    s_waitcnt lgkmcnt(0)
    s_barrier
    s_waitcnt vmcnt(8)
    v_mfma_f32_32x32x16_bf16 v[224:239], a[152:155], v[132:135], v[224:239]
    ds_read_b128 v[32:35], v12 offset:0
    ds_read_b128 v[36:39], v12 offset:1024
    ds_read_b128 v[40:43], v12 offset:8192
    ds_read_b128 v[44:47], v12 offset:9216
    v_mfma_f32_32x32x16_bf16 v[240:255], a[156:159], v[132:135], v[240:255]
    ds_read_b128 v[48:51], v12 offset:16384
    ds_read_b128 v[52:55], v12 offset:17408
    ds_read_b128 v[56:59], v12 offset:24576
    ds_read_b128 v[60:63], v12 offset:25600
    s_waitcnt vmcnt(7)
    v_mfma_f32_32x32x16_bf16 v[224:239], a[160:163], v[136:139], v[224:239]
    s_waitcnt lgkmcnt(5)
    v_add_f32 v32, v32, v40
    v_add_f32 v33, v33, v41
    v_add_f32 v34, v34, v42
    v_add_f32 v35, v35, v43
    s_waitcnt lgkmcnt(4)
    v_add_f32 v36, v36, v44
    v_mfma_f32_32x32x16_bf16 v[240:255], a[164:167], v[136:139], v[240:255]
    v_add_f32 v37, v37, v45
    v_add_f32 v38, v38, v46
    v_add_f32 v39, v39, v47
    s_waitcnt lgkmcnt(1)
    v_add_f32 v48, v48, v56
    v_add_f32 v49, v49, v57
    s_waitcnt vmcnt(6)
    v_mfma_f32_32x32x16_bf16 v[224:239], a[168:171], v[140:143], v[224:239]
    v_add_f32 v50, v50, v58
    v_add_f32 v51, v51, v59
    s_waitcnt lgkmcnt(0)
    v_add_f32 v52, v52, v60
    v_add_f32 v53, v53, v61
    v_add_f32 v54, v54, v62
    v_mfma_f32_32x32x16_bf16 v[240:255], a[172:175], v[140:143], v[240:255]
    v_add_f32 v55, v55, v63
    v_add_f32 v32, v32, v48
    v_add_f32 v33, v33, v49
    v_add_f32 v34, v34, v50
    v_add_f32 v35, v35, v51
    s_waitcnt vmcnt(5)
    v_mfma_f32_32x32x16_bf16 v[224:239], a[176:179], v[144:147], v[224:239]
    v_add_f32 v36, v36, v52
    v_add_f32 v37, v37, v53
    v_add_f32 v38, v38, v54
    v_add_f32 v39, v39, v55
    v_mfma_f32_32x32x16_bf16 v[240:255], a[180:183], v[144:147], v[240:255]
    v_cvt_pk_bf16_f32 v76, v32, v33
    v_cvt_pk_bf16_f32 v77, v34, v35
    v_cvt_pk_bf16_f32 v78, v36, v37
    v_cvt_pk_bf16_f32 v79, v38, v39
    s_waitcnt vmcnt(4)
    v_mfma_f32_32x32x16_bf16 v[240:255], a[188:191], v[148:151], v[240:255]
    s_cmp_lg_u32 s60, 0
    s_cbranch_scc1 L_dual_31_l
    buffer_store_dwordx4 v[72:75], v2, s[40:43], s64 offen offset:0 sc1
    buffer_store_dwordx4 v[76:79], v2, s[40:43], s64 offen offset:1024 sc1
    s_branch L_dual_31_e
L_dual_31_l:
    buffer_store_dwordx4 v[72:75], v2, s[40:43], s64 offen offset:0
    buffer_store_dwordx4 v[76:79], v2, s[40:43], s64 offen offset:1024
L_dual_31_e:
    s_waitcnt vmcnt(5)
    v_mfma_f32_32x32x16_bf16 v[240:255], a[196:199], v[152:155], v[240:255]
    s_waitcnt vmcnt(4)
    v_mfma_f32_32x32x16_bf16 v[240:255], a[204:207], v[156:159], v[240:255]
    s_waitcnt vmcnt(3)
    v_mfma_f32_32x32x16_bf16 v[240:255], a[212:215], v[160:163], v[240:255]
    s_waitcnt vmcnt(2)
    v_mfma_f32_32x32x16_bf16 v[240:255], a[220:223], v[164:167], v[240:255]
    v_mfma_f32_32x32x16_bf16 v[224:239], a[184:187], v[148:151], v[224:239]
    s_waitcnt vmcnt(0)
    s_mov_b64 exec, 1
    s_cmp_lg_u32 s60, 0
    s_cbranch_scc1 L_dual_32_l
    buffer_store_dword v121, v3, s[40:43], s69 offen sc1
    s_branch L_dual_32_e
L_dual_32_l:
    buffer_store_dword v121, v3, s[40:43], s69 offen
L_dual_32_e:
    s_mov_b64 exec, -1
    v_mfma_f32_32x32x16_bf16 v[224:239], a[192:195], v[152:155], v[224:239]
    v_mfma_f32_32x32x16_bf16 v[224:239], a[200:203], v[156:159], v[224:239]
    v_mfma_f32_32x32x16_bf16 v[224:239], a[208:211], v[160:163], v[224:239]
    s_nop 1
    ds_write_b128 v18, v[240:243] offset:32768
    ds_write_b128 v18, v[244:247] offset:33792
    v_mfma_f32_32x32x16_bf16 v[224:239], a[216:219], v[164:167], v[224:239]
    ds_write_b128 v19, v[248:251] offset:34816
    ds_write_b128 v19, v[252:255] offset:35840
    s_add_u32 s88, s66, 0
    s_mov_b64 exec, 0xffff
    buffer_load_dword v113, v3, s[40:43], s88 offen sc1
    s_mov_b64 exec, -1
L_noci_33:
    s_nop 5
    ds_write_b128 v16, v[224:227] offset:32768
    ds_write_b128 v16, v[228:231] offset:33792
    ds_write_b128 v17, v[232:235] offset:34816
    ds_write_b128 v17, v[236:239] offset:35840
    s_mov_b64 exec, 0x1
    s_waitcnt vmcnt(0)
    v_cmp_ne_u32 vcc, s36, v113
    s_nop 0
    s_cbranch_vccz L_chk_34_x
    s_add_u32 s88, s66, 0
L_chk_34:
    buffer_load_dword v113, v3, s[40:43], s88 offen sc1
    s_add_u32 s59, s59, 1
    s_cmp_gt_u32 s59, 400000
    s_cbranch_scc1 L_chk_34_y
    s_waitcnt vmcnt(0)
    v_cmp_ne_u32 vcc, s36, v113
    s_nop 0
    s_cbranch_vccnz L_chk_34
L_chk_34_y:
    s_waitcnt vmcnt(0)
L_chk_34_x:
    s_mov_b64 exec, -1
L_chk_34_z:
    buffer_load_dwordx4 v[72:75], v2, s[40:43], s65 offen offset:0 sc1
    buffer_load_dwordx4 v[76:79], v2, s[40:43], s65 offen offset:1024 sc1
    s_waitcnt lgkmcnt(0)
    s_barrier
    ds_read_b128 v[32:35], v12 offset:32768
    ds_read_b128 v[36:39], v12 offset:33792
    ds_read_b128 v[40:43], v12 offset:40960
    ds_read_b128 v[44:47], v12 offset:41984
    ds_read_b128 v[48:51], v12 offset:49152
    ds_read_b128 v[52:55], v12 offset:50176
    ds_read_b128 v[56:59], v12 offset:57344
    ds_read_b128 v[60:63], v12 offset:58368
    v_mov_b32 v30, s84
    s_waitcnt lgkmcnt(5)
    v_add_f32 v32, v32, v40
    v_add_f32 v33, v33, v41
    v_add_f32 v34, v34, v42
    v_add_f32 v35, v35, v43
    s_waitcnt lgkmcnt(4)
    v_add_f32 v36, v36, v44
    v_add_f32 v37, v37, v45
    v_add_f32 v38, v38, v46
    v_add_f32 v39, v39, v47
    s_waitcnt lgkmcnt(1)
    v_add_f32 v48, v48, v56
    v_add_f32 v49, v49, v57
    v_add_f32 v50, v50, v58
    v_add_f32 v51, v51, v59
    s_waitcnt lgkmcnt(0)
    v_add_f32 v52, v52, v60
    v_add_f32 v53, v53, v61
    v_add_f32 v54, v54, v62
    v_add_f32 v55, v55, v63
    v_add_f32 v32, v32, v48
    v_add_f32 v33, v33, v49
    v_add_f32 v34, v34, v50
    v_add_f32 v35, v35, v51
    v_add_f32 v36, v36, v52
    v_add_f32 v37, v37, v53
    v_add_f32 v38, v38, v54
    v_add_f32 v39, v39, v55
    s_waitcnt vmcnt(1)
    v_lshlrev_b32 v28, 16, v72
    v_and_b32 v29, 0xffff0000, v72
    v_pk_add_f32 v[64:65], v[64:65], v[28:29]
    v_pk_mul_f32 v[64:65], v[64:65], v[30:31] op_sel_hi:[1,0]
    v_cvt_pk_bf16_f32 v72, v64, v65
    v_lshlrev_b32 v28, 16, v73
    v_and_b32 v29, 0xffff0000, v73
    v_pk_add_f32 v[66:67], v[66:67], v[28:29]
    v_pk_mul_f32 v[66:67], v[66:67], v[30:31] op_sel_hi:[1,0]
    v_cvt_pk_bf16_f32 v73, v66, v67
    v_lshlrev_b32 v28, 16, v74
    v_and_b32 v29, 0xffff0000, v74
    v_pk_add_f32 v[68:69], v[68:69], v[28:29]
    v_pk_mul_f32 v[68:69], v[68:69], v[30:31] op_sel_hi:[1,0]
    v_cvt_pk_bf16_f32 v74, v68, v69
    v_lshlrev_b32 v28, 16, v75
    v_and_b32 v29, 0xffff0000, v75
    v_pk_add_f32 v[70:71], v[70:71], v[28:29]
    v_pk_mul_f32 v[70:71], v[70:71], v[30:31] op_sel_hi:[1,0]
    v_cvt_pk_bf16_f32 v75, v70, v71
    buffer_store_dwordx4 v[72:75], v13, s[32:35], s73 offen sc1
    s_waitcnt vmcnt(1)
    v_lshlrev_b32 v28, 16, v76
    v_and_b32 v29, 0xffff0000, v76
    v_pk_add_f32 v[32:33], v[32:33], v[28:29]
    v_pk_mul_f32 v[32:33], v[32:33], v[30:31] op_sel_hi:[1,0]
    v_cvt_pk_bf16_f32 v76, v32, v33
    v_lshlrev_b32 v28, 16, v77
    v_and_b32 v29, 0xffff0000, v77
    v_pk_add_f32 v[34:35], v[34:35], v[28:29]
    v_pk_mul_f32 v[34:35], v[34:35], v[30:31] op_sel_hi:[1,0]
    v_cvt_pk_bf16_f32 v77, v34, v35
    v_lshlrev_b32 v28, 16, v78
    v_and_b32 v29, 0xffff0000, v78
    v_pk_add_f32 v[36:37], v[36:37], v[28:29]
    v_pk_mul_f32 v[36:37], v[36:37], v[30:31] op_sel_hi:[1,0]
    v_cvt_pk_bf16_f32 v78, v36, v37
    v_lshlrev_b32 v28, 16, v79
    v_and_b32 v29, 0xffff0000, v79
    v_pk_add_f32 v[38:39], v[38:39], v[28:29]
    v_pk_mul_f32 v[38:39], v[38:39], v[30:31] op_sel_hi:[1,0]
    v_cvt_pk_bf16_f32 v79, v38, v39
    s_add_u32 s73, s73, 65536
    buffer_store_dwordx4 v[76:79], v13, s[32:35], s73 offen sc1
L_end:
    s_endpgm
.section .rodata,"a"
.p2align 6
.amdhsa_kernel sequential_preLN__linear_kernel_hedgehog__dense_activation_mish__prompt_kernel
  .amdhsa_next_free_vgpr 512
  .amdhsa_next_free_sgpr 102
  .amdhsa_accum_offset 256
  .amdhsa_group_segment_fixed_size 0
  .amdhsa_kernarg_size 88
  .amdhsa_user_sgpr_count 2
  .amdhsa_user_sgpr_kernarg_segment_ptr 1
  .amdhsa_system_sgpr_workgroup_id_x 1
  .amdhsa_float_denorm_mode_32 3
.end_amdhsa_kernel
```
